```python
import torch

def _softmax(x, axis=-1):
    return torch.softmax(x, dim=axis)
def _gelu(x):
    return torch.nn.functional.gelu(x, approximate="tanh")
def _silu(x):
    return torch.nn.functional.silu(x)
def _sigmoid(x):
    return torch.sigmoid(x)
def _layernorm(x, axis=-1, eps=1e-5):
    m = x.mean(dim=axis, keepdim=True)
    v = x.var(dim=axis, keepdim=True, unbiased=False)
    return (x - m) / torch.sqrt(v + eps)
def _scatter_add(tgt, idx, src, axis=0):
    return tgt.clone().index_add_(axis, idx, src)
def _segment_sum(src, seg, n):
    out = torch.zeros((n,) + src.shape[1:], dtype=src.dtype)
    return out.index_add_(0, seg, src)
def _pad(x, pw):
    flat = tuple(v for pair in reversed(pw) for v in pair)
    return torch.nn.functional.pad(x, flat)

kernel_name = 'gated_mix__linear_attn_block__linear_kernel_hedgehog__prompt'

def setup_inputs():

    _w = (lambda a: (lambda t: t.to(torch.bfloat16) if t.is_floating_point() else t)(torch.as_tensor(a)))
    def _A_setup():
        B, S, D = 1, 2048, 512
        return {
            "x": _w((lambda *s: torch.randn(*s, dtype=torch.bfloat16) * 0.05)(B, S, D)),
            "wqkv": _w((lambda *s: torch.randn(*s, dtype=torch.bfloat16) * 0.4)(D, 3 * D)),
            "wo": _w((lambda *s: torch.randn(*s, dtype=torch.bfloat16) * 0.1)(D, D)),
        }
    _A_in = _A_setup()

    def _B_setup():
        B, S, D, H = 1, 2048, 512, 32
        Dh = D // H
        return {
            "x": _w((lambda *s: torch.randn(*s, dtype=torch.bfloat16) * 0.05)(B, S, D)),
            "wqkv": _w((lambda *s: torch.randn(*s, dtype=torch.bfloat16) * 0.8)(D, 3 * D)),
            "w_phi": _w((lambda *s: torch.randn(*s, dtype=torch.bfloat16) * 0.8)(H, Dh, Dh) * (Dh ** -0.5)),
            "wo": _w((lambda *s: torch.randn(*s, dtype=torch.bfloat16) * 0.05)(D, D)),
        }
    _B_in = _B_setup()

    return {
        "A_x": _A_in["x"],
        "A_wqkv": _A_in["wqkv"],
        "A_wo": _A_in["wo"],
        "B_x": _B_in["x"],
        "B_wqkv": _B_in["wqkv"],
        "B_w_phi": _B_in["w_phi"],
        "B_wo": _B_in["wo"],
        "gate_w": _w((lambda *s: torch.randn(*s, dtype=torch.bfloat16) * 0.05)(512) * 16.0),
    }

def reference(A_x, A_wqkv, A_wo, B_x, B_wqkv, B_w_phi, B_wo, gate_w):
    def _A_ref(x, wqkv, wo):
        B, S, D = x.shape
        H = 32; Dh = D // H
        qkv = (lambda x, *d: x.permute(*d))((x @ wqkv).reshape(B, S, 3, H, Dh), 2, 0, 3, 1, 4)
        q, k, v = qkv[0], qkv[1], qkv[2]
        phi = lambda t: torch.where(t > 0, t + 1, torch.exp(t)) + 1e-6
        pq, pk = phi(q), phi(k)
        kv = torch.einsum("bhsd,bhse->bhde", pk, v)
        z = torch.einsum("bhsd->bhd", pk)
        num = torch.einsum("bhqd,bhde->bhqe", pq, kv)
        den = torch.einsum("bhqd,bhd->bhq", pq, z)[..., None] + 1e-6
        o = num / den
        return (lambda x, *d: x.permute(*d))(o, 0, 2, 1, 3).reshape(B, S, D) @ wo

    def _B_ref(x, wqkv, w_phi, wo):
        B, S, D = x.shape
        H = 32; Dh = D // H
        qkv = (lambda x, *d: x.permute(*d))((x @ wqkv).reshape(B, S, 3, H, Dh), 2, 0, 3, 1, 4)
        q, k, v = qkv[0], qkv[1], qkv[2]
        pq = torch.einsum("bhsd,hdf->bhsf", q, w_phi)
        pk = torch.einsum("bhsd,hdf->bhsf", k, w_phi)
        phi_q = torch.concatenate([_softmax(pq, axis=-1), _softmax(-pq, axis=-1)], axis=-1)
        phi_k = torch.concatenate([_softmax(pk, axis=-1), _softmax(-pk, axis=-1)], axis=-1)
        kv = torch.einsum("bhsf,bhsd->bhfd", phi_k, v)
        z  = torch.einsum("bhsf->bhf", phi_k)
        num = torch.einsum("bhqf,bhfd->bhqd", phi_q, kv)
        den = torch.einsum("bhqf,bhf->bhq", phi_q, z)[..., None] + 1e-6
        o = num / den
        return (lambda x, *d: x.permute(*d))(o, 0, 2, 1, 3).reshape(B, S, D) @ wo

    x = A_x
    g = _sigmoid((x * gate_w).sum(-1, keepdims=True))
    a = _A_ref(x, A_wqkv, A_wo)
    b = _B_ref(x, B_wqkv, B_w_phi, B_wo)
    return g * a + (1 - g) * b
```

```asm
; @launch grid=(256,1,1) block=(512,1,1) lds=163840
.amdgcn_target "amdgcn-amd-amdhsa--gfx950"
.text
.globl gated_mix__linear_attn_block__linear_kernel_hedgehog__prompt_kernel
.p2align 8
.type gated_mix__linear_attn_block__linear_kernel_hedgehog__prompt_kernel,@function
gated_mix__linear_attn_block__linear_kernel_hedgehog__prompt_kernel:
L_code_begin:
    s_cmp_ge_u32 s2, 256
    s_cbranch_scc1 L_end
    s_load_dwordx2 s[4:5], s[0:1], 0
    s_load_dwordx2 s[8:9], s[0:1], 8
    s_load_dwordx2 s[12:13], s[0:1], 32
    s_getpc_b64 s[56:57]
    v_and_b32 v61, 31, v0
    v_lshlrev_b32 v61, 6, v61
    v_mov_b32 v63, s57
    v_add_co_u32 v62, vcc, s56, v61
    s_nop 1
    v_addc_co_u32 v63, vcc, 0, v63, vcc
    global_load_dword v59, v[62:63], off
    v_lshrrev_b32 v19, 6, v0
    v_and_b32 v0, 63, v0
    s_lshr_b32 s55, s2, 3
    v_readfirstlane_b32 s44, v19
    s_and_b32 s49, s55, 7
    s_and_b32 s40, s2, 1
    s_lshl_b32 s40, s40, 3
    s_add_u32 s40, s40, s49
    v_lshrrev_b32 v28, 3, v0
    v_and_b32 v29, 7, v0
    v_lshrrev_b32 v27, 4, v0
    s_lshl_b32 s56, s40, 7
    s_lshl_b32 s57, s44, 4
    s_add_u32 s56, s56, s57
    v_add_u32 v28, s56, v28
    v_lshlrev_b32 v28, 10, v28
    v_xor_b32 v30, v29, v27
    v_lshl_add_u32 v1, v30, 4, v28
    s_lshl_b32 s76, s44, 11
    v_xor_b32 v2, 64, v1
    s_mov_b32 s6, 0x200000
    s_mov_b32 s7, 0x20000
    v_add_u32 v2, 0x2000, v2
    s_mov_b32 m0, s76
    s_waitcnt lgkmcnt(0)
    buffer_load_dwordx4 v1, s[4:7], 0 offen lds
    s_add_u32 m0, s76, 1024
    s_lshr_b32 s48, s55, 3
    buffer_load_dwordx4 v2, s[4:7], 0 offen lds
    s_bfe_u32 s41, s2, 0x20001
    s_lshl_b32 s41, s41, 2
    s_add_u32 s41, s41, s48
    s_and_b32 s42, s41, 1
    s_lshr_b32 s41, s41, 1
    v_and_b32 v26, 15, v0
    s_and_b32 s57, s44, 1
    s_lshl_b32 s55, s57, 2
    v_or_b32 v28, s55, v27
    v_lshrrev_b32 v29, 1, v26
    v_xor_b32 v28, v29, v28
    v_lshrrev_b32 v29, 2, v28
    v_lshlrev_b32 v29, 10, v29
    v_and_b32 v28, 3, v28
    v_lshl_add_u32 v29, v28, 5, v29
    v_and_b32 v28, 1, v0
    v_lshl_add_u32 v29, v28, 4, v29
    s_lshl_b32 s55, s44, 3
    v_add_u32 v28, s55, v27
    v_mul_u32_u24 v28, 0xc00, v28
    s_lshl_b32 s56, s41, 7
    s_add_u32 s56, s56, 1024
    v_add3_u32 v3, v28, v29, s56
    s_cmp_eq_u32 s42, 1
    s_cselect_b32 s54, s12, s8
    s_cselect_b32 s55, s13, s9
    s_cselect_b32 s12, s8, s12
    s_cselect_b32 s13, s9, s13
    s_mov_b32 s8, s54
    s_mov_b32 s9, s55
    s_mov_b32 s10, 0x180000
    s_mov_b32 s11, 0x20000
    s_add_u32 m0, s76, 0x4000
    v_add_u32 v4, 0x3000, v3
    buffer_load_dwordx4 v3, s[8:11], 0 offen lds
    s_add_u32 m0, s76, 0x4400
    s_mov_b32 s14, 0x180000
    buffer_load_dwordx4 v4, s[8:11], 0 offen lds
    s_lshl_b32 s43, s48, 1
    s_add_u32 s43, s43, s49
    s_and_b32 s43, s43, 7
    s_cmp_eq_u32 s43, 7
    s_cselect_b32 s43, 0, s43
    s_mov_b32 s15, 0x20000
    s_add_u32 s54, s43, 0
    s_cmp_ge_u32 s54, 7
    s_cselect_b32 s55, 7, 0
    s_sub_u32 s54, s54, s55
    s_add_u32 s54, s54, 1
    s_lshl_b32 s61, s54, 7
    s_mul_i32 s69, s54, 0x30000
    s_add_u32 m0, s76, 32768
    s_nop 0
    buffer_load_dwordx4 v1, s[4:7], s61 offen lds
    s_add_u32 m0, s76, 49152
    s_nop 0
    buffer_load_dwordx4 v3, s[8:11], s69 offen lds
    s_add_u32 m0, s76, 33792
    s_nop 0
    buffer_load_dwordx4 v2, s[4:7], s61 offen lds
    s_add_u32 m0, s76, 50176
    s_nop 0
    buffer_load_dwordx4 v4, s[8:11], s69 offen lds
    s_load_dwordx2 s[24:25], s[0:1], 80
    s_load_dwordx2 s[32:33], s[0:1], 40
    s_load_dwordx2 s[16:17], s[0:1], 16
    s_load_dwordx2 s[20:21], s[0:1], 48
    s_load_dwordx2 s[36:37], s[0:1], 56
    s_load_dwordx2 s[28:29], s[0:1], 64
    s_lshr_b32 s54, s2, 3
    s_lshl_b32 s54, s54, 3
    s_add_u32 s54, s54, s44
    s_lshl_b32 s54, s54, 8
    v_and_b32 v61, 1, v0
    v_lshlrev_b32 v61, 7, v61
    v_add_u32 v61, s54, v61
    s_getpc_b64 s[56:57]
Lpc_1:
    s_sub_u32 s56, s56, (Lpc_1-L_code_begin)
    s_subb_u32 s57, s57, 0
    v_min_u32 v61, (L_code_end-L_code_begin-4), v61
    v_mov_b32 v63, s57
    v_add_co_u32 v62, vcc, s56, v61
    s_nop 1
    v_addc_co_u32 v63, vcc, 0, v63, vcc
    global_load_dword v60, v[62:63], off
    s_mov_b32 s60, 0
    s_mov_b32 s68, 0
    s_lshr_b32 s45, s44, 2
    s_and_b32 s46, s44, 3
    s_and_b32 s54, s2, 7
    s_lshr_b32 s55, s2, 3
    s_lshr_b32 s48, s55, 2
    s_and_b32 s49, s55, 3
    s_lshl_b32 s47, s54, 2
    s_add_u32 s47, s47, s49
    s_add_u32 s49, s49, s48
    s_lshl_b32 s77, s44, 10
    s_lshl_b32 s78, s46, 11
    s_lshl_b32 s79, s45, 15
    v_lshlrev_b32 v18, 4, v0
    s_mov_b32 s26, 0x500000
    s_mov_b32 s27, 0x20000
    s_mov_b32 s34, 0x4000
    s_mov_b32 s35, 0x20000
    s_mov_b32 s18, 0x80000
    s_mov_b32 s19, 0x20000
    s_mov_b32 s22, 0x80000
    s_mov_b32 s23, 0x20000
    s_mov_b32 s38, 0x400
    s_mov_b32 s39, 0x20000
    s_mov_b32 s30, 0x200000
    s_mov_b32 s31, 0x20000
    s_waitcnt lgkmcnt(0)
    s_lshl_b32 s54, s41, 2
    s_lshl_b32 s55, s45, 1
    s_add_u32 s54, s54, s55
    s_lshl_b32 s54, s54, 9
    v_lshlrev_b32 v28, 5, v26
    v_lshl_add_u32 v28, v27, 3, v28
    v_add_u32 v28, s54, v28
    buffer_load_dwordx2 v[32:33], v28, s[32:35], 0 offen
    buffer_load_dwordx2 v[34:35], v28, s[32:35], 0 offen offset:512
    v_mov_b32 v29, 0
    buffer_load_dwordx2 v[48:49], v29, s[24:27], 0 offen
    s_cmp_gt_u32 s44, 4
    s_cbranch_scc1 Lfe_3
    v_mov_b32 v44, -1
    v_mov_b32 v45, -1
    v_mov_b32 v46, -1
    v_mov_b32 v47, -1
    s_lshl_b32 s56, s41, 4
    s_add_u32 s56, s56, s40
    s_lshl_b32 s55, 2, s42
    s_cmp_ge_u32 s44, s55
    s_cbranch_scc1 Lfz_2
    s_add_u32 s55, s42, 1
    s_lshl_b32 s54, s56, s55
    s_add_u32 s54, s54, s44
    s_lshl_b32 s54, s54, 10
    s_mov_b32 s55, 0xa0000
    s_cmp_eq_u32 s42, 0
    s_cselect_b32 s55, s55, 0x10000
    s_add_u32 s54, s54, s55
    v_add_u32 v30, s54, v18
    buffer_store_dwordx4 v[44:47], v30, s[24:27], 0 offen sc1
Lfz_2:
    s_cmp_lg_u32 s44, 4
    s_cbranch_scc1 Lfe_3
    s_add_u32 s55, s42, 8
    s_lshl_b32 s54, s56, s55
    s_mov_b32 s55, 0xe0000
    s_cmp_eq_u32 s42, 0
    s_cselect_b32 s55, s55, 0x90000
    s_add_u32 s54, s54, s55
    v_add_u32 v30, s54, v18
    s_cmp_eq_u32 s42, 0
    s_cselect_b32 exec_lo, 0xffff, -1
    s_mov_b32 exec_hi, 0
    buffer_store_dwordx4 v[44:47], v30, s[24:27], 0 offen sc1
    s_mov_b64 exec, -1
Lfe_3:
    s_add_u32 s54, s43, 1
    s_cmp_ge_u32 s54, 7
    s_cselect_b32 s55, 7, 0
    s_sub_u32 s54, s54, s55
    s_add_u32 s54, s54, 1
    s_lshl_b32 s62, s54, 7
    s_mul_i32 s70, s54, 0x30000
    s_add_u32 s54, s43, 2
    s_cmp_ge_u32 s54, 7
    s_cselect_b32 s55, 7, 0
    s_sub_u32 s54, s54, s55
    s_add_u32 s54, s54, 1
    s_lshl_b32 s63, s54, 7
    s_mul_i32 s71, s54, 0x30000
    s_add_u32 s54, s43, 3
    s_cmp_ge_u32 s54, 7
    s_cselect_b32 s55, 7, 0
    s_sub_u32 s54, s54, s55
    s_add_u32 s54, s54, 1
    s_lshl_b32 s64, s54, 7
    s_mul_i32 s72, s54, 0x30000
    s_add_u32 s54, s43, 4
    s_cmp_ge_u32 s54, 7
    s_cselect_b32 s55, 7, 0
    s_sub_u32 s54, s54, s55
    s_add_u32 s54, s54, 1
    s_lshl_b32 s65, s54, 7
    s_mul_i32 s73, s54, 0x30000
    s_add_u32 s54, s43, 5
    s_cmp_ge_u32 s54, 7
    s_cselect_b32 s55, 7, 0
    s_sub_u32 s54, s54, s55
    s_add_u32 s54, s54, 1
    s_lshl_b32 s66, s54, 7
    s_mul_i32 s74, s54, 0x30000
    s_add_u32 s54, s43, 6
    s_cmp_ge_u32 s54, 7
    s_cselect_b32 s55, 7, 0
    s_sub_u32 s54, s54, s55
    s_add_u32 s54, s54, 1
    s_lshl_b32 s67, s54, 7
    s_mul_i32 s75, s54, 0x30000
    s_add_u32 s54, s49, 0
    s_and_b32 s54, s54, 3
    s_lshl_b32 s80, s54, 17
    s_add_u32 s54, s49, 1
    s_and_b32 s54, s54, 3
    s_lshl_b32 s81, s54, 17
    s_add_u32 s54, s49, 2
    s_and_b32 s54, s54, 3
    s_lshl_b32 s82, s54, 17
    s_add_u32 s54, s49, 3
    s_and_b32 s54, s54, 3
    s_lshl_b32 s83, s54, 17
    s_and_b32 s57, s44, 1
    s_lshl_b32 s55, s57, 1
    v_and_b32 v28, 1, v27
    v_or_b32 v28, s55, v28
    v_bfe_u32 v29, v0, 1, 2
    v_xor_b32 v28, v29, v28
    v_lshlrev_b32 v28, 5, v28
    v_and_b32 v29, 1, v0
    v_lshl_add_u32 v28, v29, 4, v28
    v_lshrrev_b32 v29, 3, v0
    s_lshl_b32 s55, s44, 3
    v_add_u32 v29, s55, v29
    v_mul_u32_u24 v29, 0xc00, v29
    s_lshl_b32 s56, s41, 7
    v_add3_u32 v5, v28, v29, s56
    s_lshl_b32 s54, s46, 5
    v_add_u32 v28, s54, v26
    v_lshlrev_b32 v28, 7, v28
    v_lshrrev_b32 v29, 1, v26
    v_xor_b32 v30, v27, v29
    v_lshl_add_u32 v8, v30, 4, v28
    v_xor_b32 v9, 64, v8
    v_lshrrev_b32 v28, 2, v26
    v_and_b32 v29, 1, v27
    v_lshl_or_b32 v29, v29, 2, v28
    v_lshl_add_u32 v30, v27, 3, v28
    v_lshlrev_b32 v30, 8, v30
    v_and_b32 v31, 3, v26
    v_lshl_add_u32 v30, v31, 3, v30
    v_add_u32 v30, 0x4000, v30
    s_lshl_b32 s54, s45, 1
    s_add_u32 s55, s54, 0
    v_xor_b32 v19, s55, v29
    v_lshl_add_u32 v10, v19, 5, v30
    s_add_u32 s55, s54, 1
    v_xor_b32 v19, s55, v29
    v_lshl_add_u32 v11, v19, 5, v30
    s_add_u32 s55, s54, 4
    v_xor_b32 v19, s55, v29
    v_lshl_add_u32 v12, v19, 5, v30
    s_add_u32 s55, s54, 5
    v_xor_b32 v19, s55, v29
    v_lshl_add_u32 v13, v19, 5, v30
    v_lshrrev_b32 v28, 3, v26
    v_and_b32 v29, 1, v27
    v_lshl_or_b32 v29, v29, 1, v28
    v_lshrrev_b32 v28, 2, v26
    v_lshl_add_u32 v30, v27, 3, v28
    v_lshlrev_b32 v30, 7, v30
    v_lshl_add_u32 v30, v31, 3, v30
    v_add_u32 v30, 0x18000, v30
    s_add_u32 s55, s54, 0
    v_xor_b32 v19, s55, v29
    v_lshl_add_u32 v14, v19, 5, v30
    s_add_u32 s55, s54, 1
    v_xor_b32 v19, s55, v29
    v_lshl_add_u32 v15, v19, 5, v30
    v_lshrrev_b32 v28, 3, v0
    s_lshl_b32 s54, s44, 4
    v_add_u32 v28, s54, v28
    v_lshlrev_b32 v28, 10, v28
    s_lshl_b32 s55, s48, 7
    v_add_u32 v28, s55, v28
    v_and_b32 v29, 1, v0
    v_lshl_add_u32 v28, v29, 4, v28
    v_bfe_u32 v29, v0, 1, 2
    v_xor_b32 v30, v29, v27
    v_lshl_add_u32 v6, v30, 5, v28
    v_add_u32 v7, 0x2000, v6
    v_lshrrev_b32 v28, 2, v26
    v_lshl_add_u32 v30, v27, 2, v28
    v_lshlrev_b32 v30, 7, v30
    v_and_b32 v31, 3, v26
    v_lshl_add_u32 v30, v31, 3, v30
    s_lshl_b32 s54, s45, 14
    v_add_u32 v30, s54, v30
    v_and_b32 v29, 1, v27
    v_lshrrev_b32 v28, 3, v26
    v_lshl_or_b32 v29, v29, 1, v28
    s_and_b32 s54, s44, 1
    s_lshl_b32 s54, s54, 1
    s_add_u32 s55, s54, 0
    v_xor_b32 v19, s55, v29
    v_lshl_add_u32 v16, v19, 5, v30
    s_add_u32 s55, s54, 1
    v_xor_b32 v19, s55, v29
    v_lshl_add_u32 v17, v19, 5, v30
    v_mov_b32 v19, 0x3fb8aa3b
    v_lshlrev_b32 v28, 2, v27
    v_sub_u32 v28, v26, v28
    v_mov_b32 v29, 0x3f80
    v_mov_b32 v30, 0x3f800000
    v_cmp_eq_u32 vcc, 0, v28
    s_nop 1
    v_cndmask_b32 v20, 0, v29, vcc
    v_cmp_eq_u32 vcc, 1, v28
    s_nop 1
    v_cndmask_b32 v20, v20, v30, vcc
    v_cmp_eq_u32 vcc, 2, v28
    s_nop 1
    v_cndmask_b32 v21, 0, v29, vcc
    v_cmp_eq_u32 vcc, 3, v28
    s_nop 1
    v_cndmask_b32 v21, v21, v30, vcc
    s_cmp_eq_u32 s42, 1
    s_cbranch_scc1 L_type1
    s_cmp_lg_u32 s45, 1
    s_cbranch_scc1 Lpr_4
    s_setprio 1
Lpr_4:
    s_waitcnt vmcnt(8)
    s_barrier
    ds_read_b128 v[128:131], v8 offset:0
    ds_read_b128 v[132:135], v8 offset:2048
    ds_read_b64_tr_b16 v[64:65], v10 offset:0
    ds_read_b64_tr_b16 v[66:67], v10 offset:1024
    ds_read_b64_tr_b16 v[68:69], v11 offset:0
    ds_read_b64_tr_b16 v[70:71], v11 offset:1024
    ds_read_b64_tr_b16 v[72:73], v12 offset:0
    ds_read_b64_tr_b16 v[74:75], v12 offset:1024
    ds_read_b64_tr_b16 v[76:77], v13 offset:0
    ds_read_b64_tr_b16 v[78:79], v13 offset:1024
    s_waitcnt lgkmcnt(6)
    v_mfma_f32_16x16x32_bf16 v[96:99], v[128:131], v[64:67], 0
    ds_read_b128 v[136:139], v9 offset:0
    v_mfma_f32_16x16x32_bf16 v[100:103], v[132:135], v[64:67], 0
    ds_read_b128 v[140:143], v9 offset:2048
    s_add_u32 m0, s76, 65536
    s_nop 0
    buffer_load_dwordx4 v1, s[4:7], s62 offen lds
    s_waitcnt lgkmcnt(6)
    v_mfma_f32_16x16x32_bf16 v[104:107], v[128:131], v[68:71], 0
    ds_read_b64_tr_b16 v[80:81], v10 offset:8192
    v_mfma_f32_16x16x32_bf16 v[108:111], v[132:135], v[68:71], 0
    ds_read_b64_tr_b16 v[82:83], v10 offset:9216
    s_add_u32 m0, s76, 81920
    s_nop 0
    buffer_load_dwordx4 v3, s[8:11], s70 offen lds
    s_waitcnt lgkmcnt(6)
    v_mfma_f32_16x16x32_bf16 v[112:115], v[128:131], v[72:75], 0
    ds_read_b64_tr_b16 v[84:85], v11 offset:8192
    v_mfma_f32_16x16x32_bf16 v[116:119], v[132:135], v[72:75], 0
    ds_read_b64_tr_b16 v[86:87], v11 offset:9216
    s_add_u32 m0, s76, 66560
    s_nop 0
    buffer_load_dwordx4 v2, s[4:7], s62 offen lds
    s_waitcnt lgkmcnt(6)
    v_mfma_f32_16x16x32_bf16 v[120:123], v[128:131], v[76:79], 0
    ds_read_b64_tr_b16 v[88:89], v12 offset:8192
    ds_read_b64_tr_b16 v[90:91], v12 offset:9216
    v_mfma_f32_16x16x32_bf16 v[124:127], v[132:135], v[76:79], 0
    ds_read_b64_tr_b16 v[92:93], v13 offset:8192
    ds_read_b64_tr_b16 v[94:95], v13 offset:9216
    s_add_u32 m0, s76, 82944
    s_nop 0
    buffer_load_dwordx4 v4, s[8:11], s70 offen lds
    s_waitcnt lgkmcnt(6)
    v_mfma_f32_16x16x32_bf16 v[96:99], v[136:139], v[80:83], v[96:99]
    s_waitcnt vmcnt(8)
    s_barrier
    v_add_u32 v8, 0x8000, v8
    v_add_u32 v9, 0x8000, v9
    v_add_u32 v10, 0x8000, v10
    v_add_u32 v11, 0x8000, v11
    v_add_u32 v12, 0x8000, v12
    v_add_u32 v13, 0x8000, v13
    ds_read_b128 v[144:147], v8 offset:0
    v_mfma_f32_16x16x32_bf16 v[100:103], v[140:143], v[80:83], v[100:103]
    ds_read_b128 v[148:151], v8 offset:2048
    s_waitcnt lgkmcnt(6)
    v_mfma_f32_16x16x32_bf16 v[104:107], v[136:139], v[84:87], v[104:107]
    ds_read_b64_tr_b16 v[64:65], v10 offset:0
    v_mfma_f32_16x16x32_bf16 v[108:111], v[140:143], v[84:87], v[108:111]
    ds_read_b64_tr_b16 v[66:67], v10 offset:1024
    s_add_u32 m0, s76, 98304
    s_nop 0
    buffer_load_dwordx4 v1, s[4:7], s63 offen lds
    s_waitcnt lgkmcnt(6)
    v_mfma_f32_16x16x32_bf16 v[112:115], v[136:139], v[88:91], v[112:115]
    ds_read_b64_tr_b16 v[68:69], v11 offset:0
    v_mfma_f32_16x16x32_bf16 v[116:119], v[140:143], v[88:91], v[116:119]
    ds_read_b64_tr_b16 v[70:71], v11 offset:1024
    s_waitcnt lgkmcnt(6)
    v_mfma_f32_16x16x32_bf16 v[120:123], v[136:139], v[92:95], v[120:123]
    ds_read_b64_tr_b16 v[72:73], v12 offset:0
    ds_read_b64_tr_b16 v[74:75], v12 offset:1024
    s_add_u32 m0, s76, 114688
    s_nop 0
    buffer_load_dwordx4 v3, s[8:11], s71 offen lds
    v_mfma_f32_16x16x32_bf16 v[124:127], v[140:143], v[92:95], v[124:127]
    ds_read_b64_tr_b16 v[76:77], v13 offset:0
    ds_read_b64_tr_b16 v[78:79], v13 offset:1024
    s_waitcnt lgkmcnt(6)
    v_mfma_f32_16x16x32_bf16 v[96:99], v[144:147], v[64:67], v[96:99]
    ds_read_b128 v[152:155], v9 offset:0
    v_mfma_f32_16x16x32_bf16 v[100:103], v[148:151], v[64:67], v[100:103]
    ds_read_b128 v[156:159], v9 offset:2048
    s_waitcnt lgkmcnt(6)
    v_mfma_f32_16x16x32_bf16 v[104:107], v[144:147], v[68:71], v[104:107]
    ds_read_b64_tr_b16 v[80:81], v10 offset:8192
    s_add_u32 m0, s76, 99328
    s_nop 0
    buffer_load_dwordx4 v2, s[4:7], s63 offen lds
    v_mfma_f32_16x16x32_bf16 v[108:111], v[148:151], v[68:71], v[108:111]
    ds_read_b64_tr_b16 v[82:83], v10 offset:9216
    s_waitcnt lgkmcnt(6)
    v_mfma_f32_16x16x32_bf16 v[112:115], v[144:147], v[72:75], v[112:115]
    ds_read_b64_tr_b16 v[84:85], v11 offset:8192
    v_mfma_f32_16x16x32_bf16 v[116:119], v[148:151], v[72:75], v[116:119]
    ds_read_b64_tr_b16 v[86:87], v11 offset:9216
    s_waitcnt lgkmcnt(6)
    v_mfma_f32_16x16x32_bf16 v[120:123], v[144:147], v[76:79], v[120:123]
    ds_read_b64_tr_b16 v[88:89], v12 offset:8192
    ds_read_b64_tr_b16 v[90:91], v12 offset:9216
    s_add_u32 m0, s76, 115712
    s_nop 0
    buffer_load_dwordx4 v4, s[8:11], s71 offen lds
    v_mfma_f32_16x16x32_bf16 v[124:127], v[148:151], v[76:79], v[124:127]
    ds_read_b64_tr_b16 v[92:93], v13 offset:8192
    ds_read_b64_tr_b16 v[94:95], v13 offset:9216
    s_waitcnt lgkmcnt(6)
    v_mfma_f32_16x16x32_bf16 v[96:99], v[152:155], v[80:83], v[96:99]
    s_waitcnt vmcnt(4)
    s_barrier
    v_add_u32 v8, 0x8000, v8
    v_add_u32 v9, 0x8000, v9
    v_add_u32 v10, 0x8000, v10
    v_add_u32 v11, 0x8000, v11
    v_add_u32 v12, 0x8000, v12
    v_add_u32 v13, 0x8000, v13
    s_waitcnt vmcnt(8)
    v_readfirstlane_b32 s50, v48
    v_readfirstlane_b32 s51, v49
    s_nop 1
    s_add_u32 s50, s50, 1
    s_xor_b32 s51, s51, 0x9e3779b9
    s_cmp_eq_u32 s44, 5
    s_cbranch_scc1 Lout_5
Lback_6:
    ds_read_b128 v[160:163], v8 offset:0
    v_mfma_f32_16x16x32_bf16 v[100:103], v[156:159], v[80:83], v[100:103]
    ds_read_b128 v[164:167], v8 offset:2048
    s_waitcnt lgkmcnt(6)
    v_mfma_f32_16x16x32_bf16 v[104:107], v[152:155], v[84:87], v[104:107]
    ds_read_b64_tr_b16 v[64:65], v10 offset:0
    v_mfma_f32_16x16x32_bf16 v[108:111], v[156:159], v[84:87], v[108:111]
    ds_read_b64_tr_b16 v[66:67], v10 offset:1024
    s_add_u32 m0, s76, 131072
    s_nop 0
    buffer_load_dwordx4 v1, s[4:7], s64 offen lds
    s_waitcnt lgkmcnt(6)
    v_mfma_f32_16x16x32_bf16 v[112:115], v[152:155], v[88:91], v[112:115]
    ds_read_b64_tr_b16 v[68:69], v11 offset:0
    v_mfma_f32_16x16x32_bf16 v[116:119], v[156:159], v[88:91], v[116:119]
    ds_read_b64_tr_b16 v[70:71], v11 offset:1024
    s_waitcnt lgkmcnt(6)
    v_mfma_f32_16x16x32_bf16 v[120:123], v[152:155], v[92:95], v[120:123]
    ds_read_b64_tr_b16 v[72:73], v12 offset:0
    ds_read_b64_tr_b16 v[74:75], v12 offset:1024
    s_add_u32 m0, s76, 147456
    s_nop 0
    buffer_load_dwordx4 v3, s[8:11], s72 offen lds
    v_mfma_f32_16x16x32_bf16 v[124:127], v[156:159], v[92:95], v[124:127]
    ds_read_b64_tr_b16 v[76:77], v13 offset:0
    ds_read_b64_tr_b16 v[78:79], v13 offset:1024
    s_waitcnt vmcnt(11)
    v_mfma_f32_16x16x16_bf16 v[36:39], v[32:33], v[20:21], 0
    v_mfma_f32_16x16x16_bf16 v[40:43], v[34:35], v[20:21], 0
    s_waitcnt lgkmcnt(6)
    v_mfma_f32_16x16x32_bf16 v[96:99], v[160:163], v[64:67], v[96:99]
    ds_read_b128 v[168:171], v9 offset:0
    v_mfma_f32_16x16x32_bf16 v[100:103], v[164:167], v[64:67], v[100:103]
    ds_read_b128 v[172:175], v9 offset:2048
    s_waitcnt lgkmcnt(6)
    v_mfma_f32_16x16x32_bf16 v[104:107], v[160:163], v[68:71], v[104:107]
    ds_read_b64_tr_b16 v[80:81], v10 offset:8192
    s_add_u32 m0, s76, 132096
    s_nop 0
    buffer_load_dwordx4 v2, s[4:7], s64 offen lds
    v_mfma_f32_16x16x32_bf16 v[108:111], v[164:167], v[68:71], v[108:111]
    ds_read_b64_tr_b16 v[82:83], v10 offset:9216
    s_waitcnt lgkmcnt(6)
    v_mfma_f32_16x16x32_bf16 v[112:115], v[160:163], v[72:75], v[112:115]
    ds_read_b64_tr_b16 v[84:85], v11 offset:8192
    v_mfma_f32_16x16x32_bf16 v[116:119], v[164:167], v[72:75], v[116:119]
    ds_read_b64_tr_b16 v[86:87], v11 offset:9216
    s_waitcnt lgkmcnt(6)
    v_mfma_f32_16x16x32_bf16 v[120:123], v[160:163], v[76:79], v[120:123]
    ds_read_b64_tr_b16 v[88:89], v12 offset:8192
    ds_read_b64_tr_b16 v[90:91], v12 offset:9216
    s_add_u32 m0, s76, 148480
    s_nop 0
    buffer_load_dwordx4 v4, s[8:11], s72 offen lds
    v_mfma_f32_16x16x32_bf16 v[124:127], v[164:167], v[76:79], v[124:127]
    ds_read_b64_tr_b16 v[92:93], v13 offset:8192
    ds_read_b64_tr_b16 v[94:95], v13 offset:9216
    s_waitcnt lgkmcnt(6)
    v_mfma_f32_16x16x32_bf16 v[96:99], v[168:171], v[80:83], v[96:99]
    s_waitcnt vmcnt(4)
    s_barrier
    v_add_u32 v8, 0x8000, v8
    v_add_u32 v9, 0x8000, v9
    v_add_u32 v10, 0x8000, v10
    v_add_u32 v11, 0x8000, v11
    v_add_u32 v12, 0x8000, v12
    v_add_u32 v13, 0x8000, v13
    ds_read_b128 v[176:179], v8 offset:0
    v_mfma_f32_16x16x32_bf16 v[100:103], v[172:175], v[80:83], v[100:103]
    ds_read_b128 v[180:183], v8 offset:2048
    s_waitcnt lgkmcnt(6)
    v_mfma_f32_16x16x32_bf16 v[104:107], v[168:171], v[84:87], v[104:107]
    ds_read_b64_tr_b16 v[64:65], v10 offset:0
    v_mfma_f32_16x16x32_bf16 v[108:111], v[172:175], v[84:87], v[108:111]
    ds_read_b64_tr_b16 v[66:67], v10 offset:1024
    s_add_u32 m0, s76, 0
    s_nop 0
    buffer_load_dwordx4 v1, s[4:7], s65 offen lds
    s_waitcnt lgkmcnt(6)
    v_mfma_f32_16x16x32_bf16 v[112:115], v[168:171], v[88:91], v[112:115]
    ds_read_b64_tr_b16 v[68:69], v11 offset:0
    v_mfma_f32_16x16x32_bf16 v[116:119], v[172:175], v[88:91], v[116:119]
    ds_read_b64_tr_b16 v[70:71], v11 offset:1024
    s_waitcnt lgkmcnt(6)
    v_mfma_f32_16x16x32_bf16 v[120:123], v[168:171], v[92:95], v[120:123]
    ds_read_b64_tr_b16 v[72:73], v12 offset:0
    ds_read_b64_tr_b16 v[74:75], v12 offset:1024
    s_add_u32 m0, s76, 16384
    s_nop 0
    buffer_load_dwordx4 v3, s[8:11], s73 offen lds
    v_mfma_f32_16x16x32_bf16 v[124:127], v[172:175], v[92:95], v[124:127]
    ds_read_b64_tr_b16 v[76:77], v13 offset:0
    ds_read_b64_tr_b16 v[78:79], v13 offset:1024
    v_cvt_pk_bf16_f32 v22, v36, v37
    v_cvt_pk_bf16_f32 v23, v38, v39
    v_cvt_pk_bf16_f32 v24, v40, v41
    v_cvt_pk_bf16_f32 v25, v42, v43
    s_waitcnt lgkmcnt(6)
    v_mfma_f32_16x16x32_bf16 v[96:99], v[176:179], v[64:67], v[96:99]
    ds_read_b128 v[184:187], v9 offset:0
    v_mfma_f32_16x16x32_bf16 v[100:103], v[180:183], v[64:67], v[100:103]
    ds_read_b128 v[188:191], v9 offset:2048
    s_waitcnt lgkmcnt(6)
    v_mfma_f32_16x16x32_bf16 v[104:107], v[176:179], v[68:71], v[104:107]
    ds_read_b64_tr_b16 v[80:81], v10 offset:8192
    s_add_u32 m0, s76, 1024
    s_nop 0
    buffer_load_dwordx4 v2, s[4:7], s65 offen lds
    v_mfma_f32_16x16x32_bf16 v[108:111], v[180:183], v[68:71], v[108:111]
    ds_read_b64_tr_b16 v[82:83], v10 offset:9216
    s_waitcnt lgkmcnt(6)
    v_mfma_f32_16x16x32_bf16 v[112:115], v[176:179], v[72:75], v[112:115]
    ds_read_b64_tr_b16 v[84:85], v11 offset:8192
    v_mfma_f32_16x16x32_bf16 v[116:119], v[180:183], v[72:75], v[116:119]
    ds_read_b64_tr_b16 v[86:87], v11 offset:9216
    s_waitcnt lgkmcnt(6)
    v_mfma_f32_16x16x32_bf16 v[120:123], v[176:179], v[76:79], v[120:123]
    ds_read_b64_tr_b16 v[88:89], v12 offset:8192
    ds_read_b64_tr_b16 v[90:91], v12 offset:9216
    s_add_u32 m0, s76, 17408
    s_nop 0
    buffer_load_dwordx4 v4, s[8:11], s73 offen lds
    v_mfma_f32_16x16x32_bf16 v[124:127], v[180:183], v[76:79], v[124:127]
    ds_read_b64_tr_b16 v[92:93], v13 offset:8192
    ds_read_b64_tr_b16 v[94:95], v13 offset:9216
    s_waitcnt lgkmcnt(6)
    v_mfma_f32_16x16x32_bf16 v[96:99], v[184:187], v[80:83], v[96:99]
    s_waitcnt vmcnt(4)
    s_barrier
    v_add_u32 v8, 0x8000, v8
    v_add_u32 v9, 0x8000, v9
    v_add_u32 v10, 0x8000, v10
    v_add_u32 v11, 0x8000, v11
    v_add_u32 v12, 0x8000, v12
    v_add_u32 v13, 0x8000, v13
    ds_read_b128 v[192:195], v8 offset:0
    v_mfma_f32_16x16x32_bf16 v[100:103], v[188:191], v[80:83], v[100:103]
    ds_read_b128 v[196:199], v8 offset:2048
    s_waitcnt lgkmcnt(6)
    v_mfma_f32_16x16x32_bf16 v[104:107], v[184:187], v[84:87], v[104:107]
    ds_read_b64_tr_b16 v[64:65], v10 offset:0
    v_mfma_f32_16x16x32_bf16 v[108:111], v[188:191], v[84:87], v[108:111]
    ds_read_b64_tr_b16 v[66:67], v10 offset:1024
    s_add_u32 m0, s76, 32768
    s_nop 0
    buffer_load_dwordx4 v1, s[4:7], s66 offen lds
    s_waitcnt lgkmcnt(6)
    v_mfma_f32_16x16x32_bf16 v[112:115], v[184:187], v[88:91], v[112:115]
    ds_read_b64_tr_b16 v[68:69], v11 offset:0
    v_mfma_f32_16x16x32_bf16 v[116:119], v[188:191], v[88:91], v[116:119]
    ds_read_b64_tr_b16 v[70:71], v11 offset:1024
    s_waitcnt lgkmcnt(6)
    v_mfma_f32_16x16x32_bf16 v[120:123], v[184:187], v[92:95], v[120:123]
    ds_read_b64_tr_b16 v[72:73], v12 offset:0
    ds_read_b64_tr_b16 v[74:75], v12 offset:1024
    s_add_u32 m0, s76, 49152
    s_nop 0
    buffer_load_dwordx4 v3, s[8:11], s74 offen lds
    v_mfma_f32_16x16x32_bf16 v[124:127], v[188:191], v[92:95], v[124:127]
    ds_read_b64_tr_b16 v[76:77], v13 offset:0
    ds_read_b64_tr_b16 v[78:79], v13 offset:1024
    s_waitcnt lgkmcnt(6)
    v_mfma_f32_16x16x32_bf16 v[96:99], v[192:195], v[64:67], v[96:99]
    ds_read_b128 v[200:203], v9 offset:0
    v_mfma_f32_16x16x32_bf16 v[100:103], v[196:199], v[64:67], v[100:103]
    ds_read_b128 v[204:207], v9 offset:2048
    s_waitcnt lgkmcnt(6)
    v_mfma_f32_16x16x32_bf16 v[104:107], v[192:195], v[68:71], v[104:107]
    ds_read_b64_tr_b16 v[80:81], v10 offset:8192
    s_add_u32 m0, s76, 33792
    s_nop 0
    buffer_load_dwordx4 v2, s[4:7], s66 offen lds
    v_mfma_f32_16x16x32_bf16 v[108:111], v[196:199], v[68:71], v[108:111]
    ds_read_b64_tr_b16 v[82:83], v10 offset:9216
    s_waitcnt lgkmcnt(6)
    v_mfma_f32_16x16x32_bf16 v[112:115], v[192:195], v[72:75], v[112:115]
    ds_read_b64_tr_b16 v[84:85], v11 offset:8192
    v_mfma_f32_16x16x32_bf16 v[116:119], v[196:199], v[72:75], v[116:119]
    ds_read_b64_tr_b16 v[86:87], v11 offset:9216
    s_waitcnt lgkmcnt(6)
    v_mfma_f32_16x16x32_bf16 v[120:123], v[192:195], v[76:79], v[120:123]
    ds_read_b64_tr_b16 v[88:89], v12 offset:8192
    ds_read_b64_tr_b16 v[90:91], v12 offset:9216
    s_add_u32 m0, s76, 50176
    s_nop 0
    buffer_load_dwordx4 v4, s[8:11], s74 offen lds
    v_mfma_f32_16x16x32_bf16 v[124:127], v[196:199], v[76:79], v[124:127]
    ds_read_b64_tr_b16 v[92:93], v13 offset:8192
    ds_read_b64_tr_b16 v[94:95], v13 offset:9216
    s_waitcnt lgkmcnt(6)
    v_mfma_f32_16x16x32_bf16 v[96:99], v[200:203], v[80:83], v[96:99]
    s_waitcnt vmcnt(4)
    s_barrier
    v_subrev_u32 v8, 0x20000, v8
    v_subrev_u32 v9, 0x20000, v9
    v_subrev_u32 v10, 0x20000, v10
    v_subrev_u32 v11, 0x20000, v11
    v_subrev_u32 v12, 0x20000, v12
    v_subrev_u32 v13, 0x20000, v13
    ds_read_b128 v[208:211], v8 offset:0
    v_mfma_f32_16x16x32_bf16 v[100:103], v[204:207], v[80:83], v[100:103]
    ds_read_b128 v[212:215], v8 offset:2048
    s_waitcnt lgkmcnt(6)
    v_mfma_f32_16x16x32_bf16 v[104:107], v[200:203], v[84:87], v[104:107]
    ds_read_b64_tr_b16 v[64:65], v10 offset:0
    v_mfma_f32_16x16x32_bf16 v[108:111], v[204:207], v[84:87], v[108:111]
    ds_read_b64_tr_b16 v[66:67], v10 offset:1024
    s_add_u32 m0, s76, 65536
    s_nop 0
    buffer_load_dwordx4 v1, s[4:7], s67 offen lds
    s_waitcnt lgkmcnt(6)
    v_mfma_f32_16x16x32_bf16 v[112:115], v[200:203], v[88:91], v[112:115]
    ds_read_b64_tr_b16 v[68:69], v11 offset:0
    v_mfma_f32_16x16x32_bf16 v[116:119], v[204:207], v[88:91], v[116:119]
    ds_read_b64_tr_b16 v[70:71], v11 offset:1024
    s_waitcnt lgkmcnt(6)
    v_mfma_f32_16x16x32_bf16 v[120:123], v[200:203], v[92:95], v[120:123]
    ds_read_b64_tr_b16 v[72:73], v12 offset:0
    ds_read_b64_tr_b16 v[74:75], v12 offset:1024
    s_add_u32 m0, s76, 81920
    s_nop 0
    buffer_load_dwordx4 v3, s[8:11], s75 offen lds
    v_mfma_f32_16x16x32_bf16 v[124:127], v[204:207], v[92:95], v[124:127]
    ds_read_b64_tr_b16 v[76:77], v13 offset:0
    ds_read_b64_tr_b16 v[78:79], v13 offset:1024
    s_waitcnt lgkmcnt(6)
    v_mfma_f32_16x16x32_bf16 v[96:99], v[208:211], v[64:67], v[96:99]
    ds_read_b128 v[216:219], v9 offset:0
    v_mfma_f32_16x16x32_bf16 v[100:103], v[212:215], v[64:67], v[100:103]
    ds_read_b128 v[220:223], v9 offset:2048
    s_waitcnt lgkmcnt(6)
    v_mfma_f32_16x16x32_bf16 v[104:107], v[208:211], v[68:71], v[104:107]
    ds_read_b64_tr_b16 v[80:81], v10 offset:8192
    s_add_u32 m0, s76, 66560
    s_nop 0
    buffer_load_dwordx4 v2, s[4:7], s67 offen lds
    v_mfma_f32_16x16x32_bf16 v[108:111], v[212:215], v[68:71], v[108:111]
    ds_read_b64_tr_b16 v[82:83], v10 offset:9216
    s_waitcnt lgkmcnt(6)
    v_mfma_f32_16x16x32_bf16 v[112:115], v[208:211], v[72:75], v[112:115]
    ds_read_b64_tr_b16 v[84:85], v11 offset:8192
    v_mfma_f32_16x16x32_bf16 v[116:119], v[212:215], v[72:75], v[116:119]
    ds_read_b64_tr_b16 v[86:87], v11 offset:9216
    s_waitcnt lgkmcnt(6)
    v_mfma_f32_16x16x32_bf16 v[120:123], v[208:211], v[76:79], v[120:123]
    ds_read_b64_tr_b16 v[88:89], v12 offset:8192
    ds_read_b64_tr_b16 v[90:91], v12 offset:9216
    s_add_u32 m0, s76, 82944
    s_nop 0
    buffer_load_dwordx4 v4, s[8:11], s75 offen lds
    v_mfma_f32_16x16x32_bf16 v[124:127], v[212:215], v[76:79], v[124:127]
    ds_read_b64_tr_b16 v[92:93], v13 offset:8192
    ds_read_b64_tr_b16 v[94:95], v13 offset:9216
    s_waitcnt lgkmcnt(6)
    v_mfma_f32_16x16x32_bf16 v[96:99], v[216:219], v[80:83], v[96:99]
    s_waitcnt vmcnt(4)
    s_barrier
    v_add_u32 v8, 0x8000, v8
    v_add_u32 v9, 0x8000, v9
    v_add_u32 v10, 0x8000, v10
    v_add_u32 v11, 0x8000, v11
    v_add_u32 v12, 0x8000, v12
    v_add_u32 v13, 0x8000, v13
    ds_read_b128 v[224:227], v8 offset:0
    v_mfma_f32_16x16x32_bf16 v[100:103], v[220:223], v[80:83], v[100:103]
    ds_read_b128 v[228:231], v8 offset:2048
    s_waitcnt lgkmcnt(6)
    v_mfma_f32_16x16x32_bf16 v[104:107], v[216:219], v[84:87], v[104:107]
    ds_read_b64_tr_b16 v[64:65], v10 offset:0
    v_mfma_f32_16x16x32_bf16 v[108:111], v[220:223], v[84:87], v[108:111]
    ds_read_b64_tr_b16 v[66:67], v10 offset:1024
    s_waitcnt lgkmcnt(6)
    v_mfma_f32_16x16x32_bf16 v[112:115], v[216:219], v[88:91], v[112:115]
    ds_read_b64_tr_b16 v[68:69], v11 offset:0
    s_add_u32 m0, s77, 98304
    s_nop 0
    buffer_load_dwordx4 v5, s[12:15], s68 offen lds
    v_mfma_f32_16x16x32_bf16 v[116:119], v[220:223], v[88:91], v[116:119]
    ds_read_b64_tr_b16 v[70:71], v11 offset:1024
    s_waitcnt lgkmcnt(6)
    v_mfma_f32_16x16x32_bf16 v[120:123], v[216:219], v[92:95], v[120:123]
    ds_read_b64_tr_b16 v[72:73], v12 offset:0
    ds_read_b64_tr_b16 v[74:75], v12 offset:1024
    v_mfma_f32_16x16x32_bf16 v[124:127], v[220:223], v[92:95], v[124:127]
    ds_read_b64_tr_b16 v[76:77], v13 offset:0
    ds_read_b64_tr_b16 v[78:79], v13 offset:1024
    s_waitcnt lgkmcnt(6)
    v_mfma_f32_16x16x32_bf16 v[96:99], v[224:227], v[64:67], v[96:99]
    ds_read_b128 v[232:235], v9 offset:0
    v_mfma_f32_16x16x32_bf16 v[100:103], v[228:231], v[64:67], v[100:103]
    ds_read_b128 v[236:239], v9 offset:2048
    s_waitcnt lgkmcnt(6)
    v_mfma_f32_16x16x32_bf16 v[104:107], v[224:227], v[68:71], v[104:107]
    ds_read_b64_tr_b16 v[80:81], v10 offset:8192
    v_mfma_f32_16x16x32_bf16 v[108:111], v[228:231], v[68:71], v[108:111]
    ds_read_b64_tr_b16 v[82:83], v10 offset:9216
    s_waitcnt lgkmcnt(6)
    v_mfma_f32_16x16x32_bf16 v[112:115], v[224:227], v[72:75], v[112:115]
    ds_read_b64_tr_b16 v[84:85], v11 offset:8192
    s_add_u32 m0, s77, 106496
    s_nop 0
    buffer_load_dwordx4 v5, s[12:15], s69 offen lds
    v_mfma_f32_16x16x32_bf16 v[116:119], v[228:231], v[72:75], v[116:119]
    ds_read_b64_tr_b16 v[86:87], v11 offset:9216
    s_waitcnt lgkmcnt(6)
    v_mfma_f32_16x16x32_bf16 v[120:123], v[224:227], v[76:79], v[120:123]
    ds_read_b64_tr_b16 v[88:89], v12 offset:8192
    ds_read_b64_tr_b16 v[90:91], v12 offset:9216
    v_mfma_f32_16x16x32_bf16 v[124:127], v[228:231], v[76:79], v[124:127]
    ds_read_b64_tr_b16 v[92:93], v13 offset:8192
    ds_read_b64_tr_b16 v[94:95], v13 offset:9216
    s_waitcnt lgkmcnt(6)
    v_mfma_f32_16x16x32_bf16 v[96:99], v[232:235], v[80:83], v[96:99]
    s_waitcnt vmcnt(2)
    s_barrier
    v_add_u32 v8, 0x8000, v8
    v_add_u32 v9, 0x8000, v9
    v_add_u32 v10, 0x8000, v10
    v_add_u32 v11, 0x8000, v11
    v_add_u32 v12, 0x8000, v12
    v_add_u32 v13, 0x8000, v13
    ds_read_b128 v[240:243], v8 offset:0
    v_mfma_f32_16x16x32_bf16 v[100:103], v[236:239], v[80:83], v[100:103]
    ds_read_b128 v[244:247], v8 offset:2048
    s_waitcnt lgkmcnt(6)
    v_mfma_f32_16x16x32_bf16 v[104:107], v[232:235], v[84:87], v[104:107]
    ds_read_b64_tr_b16 v[64:65], v10 offset:0
    v_mfma_f32_16x16x32_bf16 v[108:111], v[236:239], v[84:87], v[108:111]
    ds_read_b64_tr_b16 v[66:67], v10 offset:1024
    s_waitcnt lgkmcnt(6)
    v_mfma_f32_16x16x32_bf16 v[112:115], v[232:235], v[88:91], v[112:115]
    ds_read_b64_tr_b16 v[68:69], v11 offset:0
    s_add_u32 m0, s77, 114688
    s_nop 0
    buffer_load_dwordx4 v5, s[12:15], s70 offen lds
    v_mfma_f32_16x16x32_bf16 v[116:119], v[236:239], v[88:91], v[116:119]
    ds_read_b64_tr_b16 v[70:71], v11 offset:1024
    s_waitcnt lgkmcnt(6)
    v_mfma_f32_16x16x32_bf16 v[120:123], v[232:235], v[92:95], v[120:123]
    ds_read_b64_tr_b16 v[72:73], v12 offset:0
    ds_read_b64_tr_b16 v[74:75], v12 offset:1024
    v_mfma_f32_16x16x32_bf16 v[124:127], v[236:239], v[92:95], v[124:127]
    ds_read_b64_tr_b16 v[76:77], v13 offset:0
    ds_read_b64_tr_b16 v[78:79], v13 offset:1024
    s_waitcnt lgkmcnt(6)
    v_mfma_f32_16x16x32_bf16 v[96:99], v[240:243], v[64:67], v[96:99]
    ds_read_b128 v[248:251], v9 offset:0
    v_mfma_f32_16x16x32_bf16 v[100:103], v[244:247], v[64:67], v[100:103]
    ds_read_b128 v[252:255], v9 offset:2048
    s_waitcnt lgkmcnt(6)
    v_mfma_f32_16x16x32_bf16 v[104:107], v[240:243], v[68:71], v[104:107]
    ds_read_b64_tr_b16 v[80:81], v10 offset:8192
    v_mfma_f32_16x16x32_bf16 v[108:111], v[244:247], v[68:71], v[108:111]
    ds_read_b64_tr_b16 v[82:83], v10 offset:9216
    s_waitcnt lgkmcnt(6)
    v_mfma_f32_16x16x32_bf16 v[112:115], v[240:243], v[72:75], v[112:115]
    ds_read_b64_tr_b16 v[84:85], v11 offset:8192
    s_add_u32 m0, s77, 122880
    s_nop 0
    buffer_load_dwordx4 v5, s[12:15], s71 offen lds
    v_mfma_f32_16x16x32_bf16 v[116:119], v[244:247], v[72:75], v[116:119]
    ds_read_b64_tr_b16 v[86:87], v11 offset:9216
    s_waitcnt lgkmcnt(6)
    v_mfma_f32_16x16x32_bf16 v[120:123], v[240:243], v[76:79], v[120:123]
    ds_read_b64_tr_b16 v[88:89], v12 offset:8192
    ds_read_b64_tr_b16 v[90:91], v12 offset:9216
    v_mfma_f32_16x16x32_bf16 v[124:127], v[244:247], v[76:79], v[124:127]
    ds_read_b64_tr_b16 v[92:93], v13 offset:8192
    ds_read_b64_tr_b16 v[94:95], v13 offset:9216
    s_waitcnt lgkmcnt(6)
    v_mfma_f32_16x16x32_bf16 v[96:99], v[248:251], v[80:83], v[96:99]
    v_mfma_f32_16x16x32_bf16 v[100:103], v[252:255], v[80:83], v[100:103]
    s_waitcnt lgkmcnt(4)
    v_mfma_f32_16x16x32_bf16 v[104:107], v[248:251], v[84:87], v[104:107]
    v_mfma_f32_16x16x32_bf16 v[108:111], v[252:255], v[84:87], v[108:111]
    s_waitcnt lgkmcnt(2)
    v_mfma_f32_16x16x32_bf16 v[112:115], v[248:251], v[88:91], v[112:115]
    v_mfma_f32_16x16x32_bf16 v[116:119], v[252:255], v[88:91], v[116:119]
    s_waitcnt lgkmcnt(0)
    v_mfma_f32_16x16x32_bf16 v[120:123], v[248:251], v[92:95], v[120:123]
    v_mfma_f32_16x16x32_bf16 v[124:127], v[252:255], v[92:95], v[124:127]
    s_barrier
    v_mov_b32 v56, -1
    v_mov_b32 v57, -1
    v_mov_b32 v58, -1
    v_mov_b32 v59, -1
    s_lshl_b32 s54, s40, 3
    s_lshl_b32 s55, s46, 1
    s_add_u32 s54, s54, s55
    s_lshl_b32 s54, s54, 5
    s_lshl_b32 s55, s41, 1
    s_add_u32 s54, s54, s55
    s_add_u32 s54, s54, s45
    s_add_u32 s54, s54, 16
    s_lshl_b32 s54, s54, 10
    s_add_u32 s54, s54, 0x100000
    v_add_u32 v12, s54, v18
    s_mov_b32 s55, 0x8000
    buffer_store_dwordx4 v[56:59], v12, s[24:27], 0 offen sc1
    buffer_store_dwordx4 v[56:59], v12, s[24:27], s55 offen sc1
    s_cmp_eq_u32 s44, 5
    s_cbranch_scc1 Lout_7
Lback_8:
    v_mov_b32 v8, 0x3fb8aa3b
    v_mov_b32 v9, 0x358637bd
    v_cvt_pk_bf16_f32 v32, v112, v113
    v_cvt_pk_bf16_f32 v33, v114, v115
    v_cvt_pk_bf16_f32 v34, v116, v117
    v_cvt_pk_bf16_f32 v35, v118, v119
    v_cvt_pk_bf16_f32 v36, v120, v121
    v_cvt_pk_bf16_f32 v37, v122, v123
    v_cvt_pk_bf16_f32 v38, v124, v125
    v_cvt_pk_bf16_f32 v39, v126, v127
    v_pk_mul_f32 v[48:49], v[96:97], v[8:9] op_sel_hi:[1,0]
    v_pk_mul_f32 v[50:51], v[98:99], v[8:9] op_sel_hi:[1,0]
    v_pk_mul_f32 v[52:53], v[100:101], v[8:9] op_sel_hi:[1,0]
    s_add_u32 m0, s77, 131072
    s_nop 0
    buffer_load_dwordx4 v5, s[12:15], s72 offen lds
    v_pk_mul_f32 v[54:55], v[102:103], v[8:9] op_sel_hi:[1,0]
    v_pk_mul_f32 v[56:57], v[104:105], v[8:9] op_sel_hi:[1,0]
    v_pk_mul_f32 v[58:59], v[106:107], v[8:9] op_sel_hi:[1,0]
    v_pk_mul_f32 v[60:61], v[108:109], v[8:9] op_sel_hi:[1,0]
    v_pk_mul_f32 v[62:63], v[110:111], v[8:9] op_sel_hi:[1,0]
    v_exp_f32_e64 v48, v48 clamp
    v_exp_f32_e64 v49, v49 clamp
    v_exp_f32_e64 v50, v50 clamp
    v_exp_f32_e64 v51, v51 clamp
    v_exp_f32_e64 v52, v52 clamp
    v_exp_f32_e64 v53, v53 clamp
    v_exp_f32_e64 v54, v54 clamp
    s_add_u32 m0, s77, 139264
    s_nop 0
    buffer_load_dwordx4 v5, s[12:15], s73 offen lds
    v_exp_f32_e64 v55, v55 clamp
    v_exp_f32_e64 v56, v56 clamp
    v_exp_f32_e64 v57, v57 clamp
    v_exp_f32_e64 v58, v58 clamp
    v_exp_f32_e64 v59, v59 clamp
    v_exp_f32_e64 v60, v60 clamp
    v_exp_f32_e64 v61, v61 clamp
    v_exp_f32_e64 v62, v62 clamp
    v_exp_f32_e64 v63, v63 clamp
    v_max_f32 v96, 0, v96
    v_max_f32 v97, 0, v97
    v_max_f32 v98, 0, v98
    s_add_u32 m0, s77, 147456
    s_nop 0
    buffer_load_dwordx4 v5, s[12:15], s74 offen lds
    v_max_f32 v99, 0, v99
    v_max_f32 v100, 0, v100
    v_max_f32 v101, 0, v101
    v_max_f32 v102, 0, v102
    v_max_f32 v103, 0, v103
    v_max_f32 v104, 0, v104
    v_max_f32 v105, 0, v105
    v_max_f32 v106, 0, v106
    v_max_f32 v107, 0, v107
    v_max_f32 v108, 0, v108
    v_max_f32 v109, 0, v109
    v_max_f32 v110, 0, v110
    s_add_u32 m0, s77, 155648
    s_nop 0
    buffer_load_dwordx4 v5, s[12:15], s75 offen lds
    v_max_f32 v111, 0, v111
    v_pk_add_f32 v[48:49], v[48:49], v[8:9] op_sel:[0,1] op_sel_hi:[1,1]
    v_pk_add_f32 v[50:51], v[50:51], v[8:9] op_sel:[0,1] op_sel_hi:[1,1]
    v_pk_add_f32 v[52:53], v[52:53], v[8:9] op_sel:[0,1] op_sel_hi:[1,1]
    v_pk_add_f32 v[54:55], v[54:55], v[8:9] op_sel:[0,1] op_sel_hi:[1,1]
    v_pk_add_f32 v[56:57], v[56:57], v[8:9] op_sel:[0,1] op_sel_hi:[1,1]
    v_pk_add_f32 v[58:59], v[58:59], v[8:9] op_sel:[0,1] op_sel_hi:[1,1]
    v_pk_add_f32 v[60:61], v[60:61], v[8:9] op_sel:[0,1] op_sel_hi:[1,1]
    v_pk_add_f32 v[62:63], v[62:63], v[8:9] op_sel:[0,1] op_sel_hi:[1,1]
    v_pk_add_f32 v[96:97], v[96:97], v[48:49]
    v_pk_add_f32 v[98:99], v[98:99], v[50:51]
    v_pk_add_f32 v[100:101], v[100:101], v[52:53]
    v_pk_add_f32 v[102:103], v[102:103], v[54:55]
    v_pk_add_f32 v[104:105], v[104:105], v[56:57]
    v_pk_add_f32 v[106:107], v[106:107], v[58:59]
    v_pk_add_f32 v[108:109], v[108:109], v[60:61]
    v_pk_add_f32 v[110:111], v[110:111], v[62:63]
    v_cvt_pk_bf16_f32 v40, v96, v97
    v_cvt_pk_bf16_f32 v41, v98, v99
    v_cvt_pk_bf16_f32 v42, v100, v101
    v_cvt_pk_bf16_f32 v43, v102, v103
    v_cvt_pk_bf16_f32 v44, v104, v105
    v_cvt_pk_bf16_f32 v45, v106, v107
    v_cvt_pk_bf16_f32 v46, v108, v109
    v_cvt_pk_bf16_f32 v47, v110, v111
    v_mov_b32 v26, 0x3f803f80
    v_mov_b32 v27, 0x3f803f80
    v_mov_b32 v28, 0x3f803f80
    v_mov_b32 v29, 0x3f803f80
    v_mfma_f32_16x16x32_bf16 v[96:99], v[40:43], v[32:35], 0
    v_mfma_f32_16x16x32_bf16 v[100:103], v[44:47], v[36:39], 0
    v_mfma_f32_16x16x32_bf16 v[104:107], v[40:43], v[26:29], 0
    v_mfma_f32_16x16x32_bf16 v[108:111], v[44:47], v[26:29], 0
    s_mov_b32 exec_lo, 0xf000f0
    s_mov_b32 exec_hi, 0xf000f0
    s_nop 5
    v_mov_b32 v104, v108
    v_mov_b32 v105, v109
    v_mov_b32 v106, v110
    v_mov_b32 v107, v111
    s_mov_b64 exec, -1
    s_lshl_b32 s54, s44, 12
    s_add_u32 s54, s54, 0x8000
    v_add_u32 v30, s54, v18
    s_lshl_b32 s54, s44, 10
    s_add_u32 s54, s54, 0x10000
    v_add_u32 v31, s54, v18
    ds_write_b128 v30, v[96:99] offset:0
    ds_write_b128 v30, v[100:103] offset:1024
    ds_write_b128 v31, v[104:107]
    s_waitcnt vmcnt(6)
    s_waitcnt lgkmcnt(0)
    s_barrier
    s_cmp_ge_u32 s44, 2
    s_cbranch_scc1 Lz_9
    s_lshl_b32 s54, s44, 14
    s_add_u32 s54, s54, 0x8000
    v_add_u32 v30, s54, v18
    ds_read_b128 v[32:35], v30 offset:0
    ds_read_b128 v[36:39], v30 offset:4096
    ds_read_b128 v[40:43], v30 offset:8192
    ds_read_b128 v[44:47], v30 offset:12288
    ds_read_b128 v[48:51], v30 offset:1024
    ds_read_b128 v[52:55], v30 offset:5120
    ds_read_b128 v[56:59], v30 offset:9216
    ds_read_b128 v[60:63], v30 offset:13312
    s_lshl_b32 s54, s41, 4
    s_add_u32 s54, s54, s40
    s_lshl_b32 s54, s54, 1
    s_add_u32 s54, s54, s44
    s_lshl_b32 s54, s54, 10
    s_add_u32 s54, s54, 0xa0000
    v_add_u32 v31, s54, v18
    s_waitcnt lgkmcnt(0)
    v_add_f32 v32, v32, v36
    v_add_f32 v33, v33, v37
    v_add_f32 v34, v34, v38
    v_add_f32 v35, v35, v39
    v_add_f32 v40, v40, v44
    v_add_f32 v41, v41, v45
    v_add_f32 v42, v42, v46
    v_add_f32 v43, v43, v47
    v_add_f32 v48, v48, v52
    v_add_f32 v49, v49, v53
    v_add_f32 v50, v50, v54
    v_add_f32 v51, v51, v55
    v_add_f32 v56, v56, v60
    v_add_f32 v57, v57, v61
    v_add_f32 v58, v58, v62
    v_add_f32 v59, v59, v63
    v_add_f32 v32, v32, v40
    v_add_f32 v33, v33, v41
    v_add_f32 v34, v34, v42
    v_add_f32 v35, v35, v43
    v_add_f32 v48, v48, v56
    v_add_f32 v49, v49, v57
    v_add_f32 v50, v50, v58
    v_add_f32 v51, v51, v59
    v_cvt_pk_bf16_f32 v26, v32, v33
    v_cvt_pk_bf16_f32 v27, v34, v35
    v_cvt_pk_bf16_f32 v28, v48, v49
    v_cvt_pk_bf16_f32 v29, v50, v51
    buffer_store_dwordx4 v[26:29], v31, s[24:27], 0 offen sc1
    s_branch Lred_10
Lz_9:
    s_cmp_lg_u32 s44, 4
    s_cbranch_scc1 Lred_10
    v_lshrrev_b32 v30, 3, v0
    v_lshlrev_b32 v30, 12, v30
    v_and_b32 v31, 3, v0
    v_lshl_add_u32 v30, v31, 8, v30
    v_bfe_u32 v31, v0, 2, 1
    v_lshl_add_u32 v30, v31, 6, v30
    v_add_u32 v30, 0x10000, v30
    s_lshl_b32 s54, s41, 4
    s_add_u32 s54, s54, s40
    s_lshl_b32 s54, s54, 8
    s_add_u32 s54, s54, 0xe0000
    v_add_u32 v31, s54, v18
    s_mov_b64 exec, 0xffff
    ds_read_b128 v[32:35], v30 offset:0
    ds_read_b128 v[36:39], v30 offset:1024
    ds_read_b128 v[40:43], v30 offset:2048
    ds_read_b128 v[44:47], v30 offset:3072
    s_waitcnt lgkmcnt(0)
    v_add_f32 v32, v32, v36
    v_add_f32 v33, v33, v37
    v_add_f32 v34, v34, v38
    v_add_f32 v35, v35, v39
    v_add_f32 v40, v40, v44
    v_add_f32 v41, v41, v45
    v_add_f32 v42, v42, v46
    v_add_f32 v43, v43, v47
    v_add_f32 v32, v32, v40
    v_add_f32 v33, v33, v41
    v_add_f32 v34, v34, v42
    v_add_f32 v35, v35, v43
    buffer_store_dwordx4 v[32:35], v31, s[24:27], 0 offen sc1
    s_mov_b64 exec, -1
Lred_10:
    ds_read_b64_tr_b16 v[64:65], v14 offset:0
    ds_read_b64_tr_b16 v[66:67], v14 offset:512
    ds_read_b64_tr_b16 v[68:69], v15 offset:0
    ds_read_b64_tr_b16 v[70:71], v15 offset:512
    ds_read_b64_tr_b16 v[72:73], v14 offset:4096
    ds_read_b64_tr_b16 v[74:75], v14 offset:4608
    ds_read_b64_tr_b16 v[76:77], v15 offset:4096
    ds_read_b64_tr_b16 v[78:79], v15 offset:4608
    s_waitcnt lgkmcnt(6)
    v_mfma_f32_16x16x32_bf16 v[96:99], v[64:67], v[128:131], 0
    ds_read_b64_tr_b16 v[80:81], v14 offset:8192
    v_mfma_f32_16x16x32_bf16 v[100:103], v[64:67], v[132:135], 0
    ds_read_b64_tr_b16 v[82:83], v14 offset:8704
    s_waitcnt lgkmcnt(6)
    v_mfma_f32_16x16x32_bf16 v[104:107], v[68:71], v[128:131], 0
    ds_read_b64_tr_b16 v[84:85], v15 offset:8192
    v_mfma_f32_16x16x32_bf16 v[108:111], v[68:71], v[132:135], 0
    ds_read_b64_tr_b16 v[86:87], v15 offset:8704
    s_add_u32 m0, s76, 0
    s_nop 0
    buffer_load_dwordx4 v6, s[16:19], s80 offen lds
    s_waitcnt lgkmcnt(6)
    v_mfma_f32_16x16x32_bf16 v[96:99], v[72:75], v[136:139], v[96:99]
    ds_read_b64_tr_b16 v[88:89], v14 offset:12288
    v_mfma_f32_16x16x32_bf16 v[100:103], v[72:75], v[140:143], v[100:103]
    ds_read_b64_tr_b16 v[90:91], v14 offset:12800
    s_waitcnt lgkmcnt(6)
    v_mfma_f32_16x16x32_bf16 v[104:107], v[76:79], v[136:139], v[104:107]
    ds_read_b64_tr_b16 v[92:93], v15 offset:12288
    s_add_u32 m0, s76, 1024
    s_nop 0
    buffer_load_dwordx4 v7, s[16:19], s80 offen lds
    v_mfma_f32_16x16x32_bf16 v[108:111], v[76:79], v[140:143], v[108:111]
    ds_read_b64_tr_b16 v[94:95], v15 offset:12800
    s_waitcnt lgkmcnt(6)
    v_mfma_f32_16x16x32_bf16 v[96:99], v[80:83], v[144:147], v[96:99]
    ds_read_b64_tr_b16 v[64:65], v14 offset:16384
    v_mfma_f32_16x16x32_bf16 v[100:103], v[80:83], v[148:151], v[100:103]
    ds_read_b64_tr_b16 v[66:67], v14 offset:16896
    s_waitcnt lgkmcnt(6)
    v_mfma_f32_16x16x32_bf16 v[104:107], v[84:87], v[144:147], v[104:107]
    ds_read_b64_tr_b16 v[68:69], v15 offset:16384
    v_mfma_f32_16x16x32_bf16 v[108:111], v[84:87], v[148:151], v[108:111]
    ds_read_b64_tr_b16 v[70:71], v15 offset:16896
    s_add_u32 m0, s76, 16384
    s_nop 0
    buffer_load_dwordx4 v6, s[20:23], s80 offen lds
    s_waitcnt lgkmcnt(6)
    v_mfma_f32_16x16x32_bf16 v[96:99], v[88:91], v[152:155], v[96:99]
    ds_read_b64_tr_b16 v[72:73], v14 offset:20480
    v_mfma_f32_16x16x32_bf16 v[100:103], v[88:91], v[156:159], v[100:103]
    ds_read_b64_tr_b16 v[74:75], v14 offset:20992
    s_waitcnt lgkmcnt(6)
    v_mfma_f32_16x16x32_bf16 v[104:107], v[92:95], v[152:155], v[104:107]
    ds_read_b64_tr_b16 v[76:77], v15 offset:20480
    s_add_u32 m0, s76, 17408
    s_nop 0
    buffer_load_dwordx4 v7, s[20:23], s80 offen lds
    v_mfma_f32_16x16x32_bf16 v[108:111], v[92:95], v[156:159], v[108:111]
    ds_read_b64_tr_b16 v[78:79], v15 offset:20992
    s_waitcnt lgkmcnt(6)
    v_mfma_f32_16x16x32_bf16 v[96:99], v[64:67], v[160:163], v[96:99]
    s_cmp_eq_u32 s44, 5
    s_cbranch_scc1 Lout_11
Lback_12:
    s_waitcnt vmcnt(4)
    s_barrier
    ds_read_b64_tr_b16 v[80:81], v14 offset:24576
    v_mfma_f32_16x16x32_bf16 v[100:103], v[64:67], v[164:167], v[100:103]
    ds_read_b64_tr_b16 v[82:83], v14 offset:25088
    s_waitcnt lgkmcnt(6)
    v_mfma_f32_16x16x32_bf16 v[104:107], v[68:71], v[160:163], v[104:107]
    ds_read_b64_tr_b16 v[84:85], v15 offset:24576
    v_mfma_f32_16x16x32_bf16 v[108:111], v[68:71], v[164:167], v[108:111]
    ds_read_b64_tr_b16 v[86:87], v15 offset:25088
    s_add_u32 m0, s76, 32768
    s_nop 0
    buffer_load_dwordx4 v6, s[16:19], s81 offen lds
    s_waitcnt lgkmcnt(6)
    v_mfma_f32_16x16x32_bf16 v[96:99], v[72:75], v[168:171], v[96:99]
    ds_read_b64_tr_b16 v[88:89], v14 offset:28672
    v_mfma_f32_16x16x32_bf16 v[100:103], v[72:75], v[172:175], v[100:103]
    ds_read_b64_tr_b16 v[90:91], v14 offset:29184
    s_waitcnt lgkmcnt(6)
    v_mfma_f32_16x16x32_bf16 v[104:107], v[76:79], v[168:171], v[104:107]
    ds_read_b64_tr_b16 v[92:93], v15 offset:28672
    s_add_u32 m0, s76, 33792
    s_nop 0
    buffer_load_dwordx4 v7, s[16:19], s81 offen lds
    v_mfma_f32_16x16x32_bf16 v[108:111], v[76:79], v[172:175], v[108:111]
    ds_read_b64_tr_b16 v[94:95], v15 offset:29184
    v_add_u32 v14, 0x8000, v14
    v_add_u32 v15, 0x8000, v15
    s_waitcnt lgkmcnt(6)
    v_mfma_f32_16x16x32_bf16 v[96:99], v[80:83], v[176:179], v[96:99]
    ds_read_b64_tr_b16 v[64:65], v14 offset:0
    v_mfma_f32_16x16x32_bf16 v[100:103], v[80:83], v[180:183], v[100:103]
    ds_read_b64_tr_b16 v[66:67], v14 offset:512
    s_waitcnt lgkmcnt(6)
    v_mfma_f32_16x16x32_bf16 v[104:107], v[84:87], v[176:179], v[104:107]
    ds_read_b64_tr_b16 v[68:69], v15 offset:0
    v_mfma_f32_16x16x32_bf16 v[108:111], v[84:87], v[180:183], v[108:111]
    ds_read_b64_tr_b16 v[70:71], v15 offset:512
    s_add_u32 m0, s76, 49152
    s_nop 0
    buffer_load_dwordx4 v6, s[20:23], s81 offen lds
    s_waitcnt lgkmcnt(6)
    v_mfma_f32_16x16x32_bf16 v[96:99], v[88:91], v[184:187], v[96:99]
    ds_read_b64_tr_b16 v[72:73], v14 offset:4096
    v_mfma_f32_16x16x32_bf16 v[100:103], v[88:91], v[188:191], v[100:103]
    ds_read_b64_tr_b16 v[74:75], v14 offset:4608
    s_waitcnt lgkmcnt(6)
    v_mfma_f32_16x16x32_bf16 v[104:107], v[92:95], v[184:187], v[104:107]
    ds_read_b64_tr_b16 v[76:77], v15 offset:4096
    s_add_u32 m0, s76, 50176
    s_nop 0
    buffer_load_dwordx4 v7, s[20:23], s81 offen lds
    v_mfma_f32_16x16x32_bf16 v[108:111], v[92:95], v[188:191], v[108:111]
    ds_read_b64_tr_b16 v[78:79], v15 offset:4608
    s_waitcnt lgkmcnt(6)
    v_mfma_f32_16x16x32_bf16 v[96:99], v[64:67], v[192:195], v[96:99]
    ds_read_b64_tr_b16 v[80:81], v14 offset:8192
    v_mfma_f32_16x16x32_bf16 v[100:103], v[64:67], v[196:199], v[100:103]
    ds_read_b64_tr_b16 v[82:83], v14 offset:8704
    s_waitcnt lgkmcnt(6)
    v_mfma_f32_16x16x32_bf16 v[104:107], v[68:71], v[192:195], v[104:107]
    ds_read_b64_tr_b16 v[84:85], v15 offset:8192
    v_mfma_f32_16x16x32_bf16 v[108:111], v[68:71], v[196:199], v[108:111]
    ds_read_b64_tr_b16 v[86:87], v15 offset:8704
    s_add_u32 m0, s76, 65536
    s_nop 0
    buffer_load_dwordx4 v6, s[16:19], s82 offen lds
    s_waitcnt lgkmcnt(6)
    v_mfma_f32_16x16x32_bf16 v[96:99], v[72:75], v[200:203], v[96:99]
    ds_read_b64_tr_b16 v[88:89], v14 offset:12288
    v_mfma_f32_16x16x32_bf16 v[100:103], v[72:75], v[204:207], v[100:103]
    ds_read_b64_tr_b16 v[90:91], v14 offset:12800
    s_waitcnt lgkmcnt(6)
    v_mfma_f32_16x16x32_bf16 v[104:107], v[76:79], v[200:203], v[104:107]
    ds_read_b64_tr_b16 v[92:93], v15 offset:12288
    s_add_u32 m0, s76, 66560
    s_nop 0
    buffer_load_dwordx4 v7, s[16:19], s82 offen lds
    v_mfma_f32_16x16x32_bf16 v[108:111], v[76:79], v[204:207], v[108:111]
    ds_read_b64_tr_b16 v[94:95], v15 offset:12800
    s_waitcnt lgkmcnt(6)
    v_mfma_f32_16x16x32_bf16 v[96:99], v[80:83], v[208:211], v[96:99]
    ds_read_b64_tr_b16 v[64:65], v14 offset:16384
    v_mfma_f32_16x16x32_bf16 v[100:103], v[80:83], v[212:215], v[100:103]
    ds_read_b64_tr_b16 v[66:67], v14 offset:16896
    s_waitcnt lgkmcnt(6)
    v_mfma_f32_16x16x32_bf16 v[104:107], v[84:87], v[208:211], v[104:107]
    ds_read_b64_tr_b16 v[68:69], v15 offset:16384
    v_mfma_f32_16x16x32_bf16 v[108:111], v[84:87], v[212:215], v[108:111]
    ds_read_b64_tr_b16 v[70:71], v15 offset:16896
    s_add_u32 m0, s76, 81920
    s_nop 0
    buffer_load_dwordx4 v6, s[20:23], s82 offen lds
    s_waitcnt lgkmcnt(6)
    v_mfma_f32_16x16x32_bf16 v[96:99], v[88:91], v[216:219], v[96:99]
    ds_read_b64_tr_b16 v[72:73], v14 offset:20480
    v_mfma_f32_16x16x32_bf16 v[100:103], v[88:91], v[220:223], v[100:103]
    ds_read_b64_tr_b16 v[74:75], v14 offset:20992
    s_waitcnt lgkmcnt(6)
    v_mfma_f32_16x16x32_bf16 v[104:107], v[92:95], v[216:219], v[104:107]
    ds_read_b64_tr_b16 v[76:77], v15 offset:20480
    s_add_u32 m0, s76, 82944
    s_nop 0
    buffer_load_dwordx4 v7, s[20:23], s82 offen lds
    v_mfma_f32_16x16x32_bf16 v[108:111], v[92:95], v[220:223], v[108:111]
    ds_read_b64_tr_b16 v[78:79], v15 offset:20992
    s_waitcnt lgkmcnt(6)
    v_mfma_f32_16x16x32_bf16 v[96:99], v[64:67], v[224:227], v[96:99]
    ds_read_b64_tr_b16 v[80:81], v14 offset:24576
    v_mfma_f32_16x16x32_bf16 v[100:103], v[64:67], v[228:231], v[100:103]
    ds_read_b64_tr_b16 v[82:83], v14 offset:25088
    s_waitcnt lgkmcnt(6)
    v_mfma_f32_16x16x32_bf16 v[104:107], v[68:71], v[224:227], v[104:107]
    ds_read_b64_tr_b16 v[84:85], v15 offset:24576
    v_mfma_f32_16x16x32_bf16 v[108:111], v[68:71], v[228:231], v[108:111]
    ds_read_b64_tr_b16 v[86:87], v15 offset:25088
    s_waitcnt lgkmcnt(6)
    v_mfma_f32_16x16x32_bf16 v[96:99], v[72:75], v[232:235], v[96:99]
    ds_read_b64_tr_b16 v[88:89], v14 offset:28672
    v_mfma_f32_16x16x32_bf16 v[100:103], v[72:75], v[236:239], v[100:103]
    ds_read_b64_tr_b16 v[90:91], v14 offset:29184
    s_waitcnt lgkmcnt(6)
    v_mfma_f32_16x16x32_bf16 v[104:107], v[76:79], v[232:235], v[104:107]
    ds_read_b64_tr_b16 v[92:93], v15 offset:28672
    v_mfma_f32_16x16x32_bf16 v[108:111], v[76:79], v[236:239], v[108:111]
    ds_read_b64_tr_b16 v[94:95], v15 offset:29184
    s_waitcnt lgkmcnt(6)
    v_mfma_f32_16x16x32_bf16 v[96:99], v[80:83], v[240:243], v[96:99]
    v_mfma_f32_16x16x32_bf16 v[100:103], v[80:83], v[244:247], v[100:103]
    s_waitcnt lgkmcnt(4)
    v_mfma_f32_16x16x32_bf16 v[104:107], v[84:87], v[240:243], v[104:107]
    v_mfma_f32_16x16x32_bf16 v[108:111], v[84:87], v[244:247], v[108:111]
    s_waitcnt lgkmcnt(2)
    v_mfma_f32_16x16x32_bf16 v[96:99], v[88:91], v[248:251], v[96:99]
    v_mfma_f32_16x16x32_bf16 v[100:103], v[88:91], v[252:255], v[100:103]
    s_waitcnt lgkmcnt(0)
    v_mfma_f32_16x16x32_bf16 v[104:107], v[92:95], v[248:251], v[104:107]
    v_mfma_f32_16x16x32_bf16 v[108:111], v[92:95], v[252:255], v[108:111]
    s_waitcnt vmcnt(4)
    s_barrier
    s_cmp_eq_u32 s44, 5
    s_cbranch_scc1 Lout_15
Lback_16:
    s_lshl_b32 s54, s41, 4
    s_and_b32 s55, s44, 1
    s_lshl_b32 s55, s55, 3
    s_add_u32 s54, s54, s55
    s_lshl_b32 s54, s54, 2
    s_lshr_b32 s55, s44, 1
    s_add_u32 s54, s54, s55
    s_lshl_b32 s54, s54, 10
    s_add_u32 s54, s54, 0x10000
    v_add_u32 v31, s54, v18
    v_cvt_pk_bf16_f32 v64, v96, v97
    ds_read_b64_tr_b16 v[128:129], v16 offset:0
    v_cvt_pk_bf16_f32 v65, v98, v99
    v_cvt_pk_bf16_f32 v66, v100, v101
    v_cvt_pk_bf16_f32 v67, v102, v103
    ds_read_b64_tr_b16 v[130:131], v16 offset:2048
    v_cvt_pk_bf16_f32 v68, v104, v105
    v_cvt_pk_bf16_f32 v69, v106, v107
    v_cvt_pk_bf16_f32 v70, v108, v109
    ds_read_b64_tr_b16 v[132:133], v17 offset:0
    v_cvt_pk_bf16_f32 v71, v110, v111
    v_mfma_f32_16x16x16_bf16 v[96:99], v[22:23], v[64:65], 0
    v_mfma_f32_16x16x16_bf16 v[100:103], v[22:23], v[66:67], 0
    ds_read_b64_tr_b16 v[134:135], v17 offset:2048
    v_mfma_f32_16x16x16_bf16 v[104:107], v[24:25], v[68:69], 0
    v_mfma_f32_16x16x16_bf16 v[108:111], v[24:25], v[70:71], 0
    s_nop 3
    v_max3_f32 v72, v96, v97, v98
    ds_read_b64_tr_b16 v[136:137], v16 offset:4096
    v_max3_f32 v73, v100, v101, v102
    v_max3_f32 v74, v104, v105, v106
    v_max3_f32 v75, v108, v109, v110
    ds_read_b64_tr_b16 v[138:139], v16 offset:6144
    v_max3_f32 v76, -v96, -v97, -v98
    v_max3_f32 v77, -v100, -v101, -v102
    v_max3_f32 v78, -v104, -v105, -v106
    ds_read_b64_tr_b16 v[140:141], v17 offset:4096
    v_max3_f32 v79, -v108, -v109, -v110
    v_max_f32 v72, v72, v99
    v_max_f32 v73, v73, v103
    ds_read_b64_tr_b16 v[142:143], v17 offset:6144
    v_max_f32 v74, v74, v107
    v_max_f32 v75, v75, v111
    v_max_f32_e64 v76, v76, -v99
    ds_read_b64_tr_b16 v[144:145], v16 offset:8192
    v_max_f32_e64 v77, v77, -v103
    v_max_f32_e64 v78, v78, -v107
    v_max_f32_e64 v79, v79, -v111
    ds_read_b64_tr_b16 v[146:147], v16 offset:10240
    v_permlane16_swap_b32 v72, v76
    v_permlane16_swap_b32 v73, v77
    v_permlane16_swap_b32 v74, v78
    ds_read_b64_tr_b16 v[148:149], v17 offset:8192
    v_permlane16_swap_b32 v75, v79
    v_max_f32 v72, v72, v76
    v_max_f32 v73, v73, v77
    ds_read_b64_tr_b16 v[150:151], v17 offset:10240
    v_max_f32 v74, v74, v78
    v_max_f32 v75, v75, v79
    v_mov_b32 v76, v72
    ds_read_b64_tr_b16 v[152:153], v16 offset:12288
    v_mov_b32 v77, v73
    v_mov_b32 v78, v74
    v_mov_b32 v79, v75
    ds_read_b64_tr_b16 v[154:155], v16 offset:14336
    v_permlane32_swap_b32 v72, v76
    v_permlane32_swap_b32 v73, v77
    v_permlane32_swap_b32 v74, v78
    ds_read_b64_tr_b16 v[156:157], v17 offset:12288
    v_permlane32_swap_b32 v75, v79
    v_max_f32 v72, v72, v76
    v_max_f32 v73, v73, v77
    ds_read_b64_tr_b16 v[158:159], v17 offset:14336
    v_max_f32 v74, v74, v78
    v_max_f32 v75, v75, v79
    v_mov_b32 v76, v72
    ds_read_b64_tr_b16 v[160:161], v16 offset:32768
    v_mov_b32 v77, v73
    v_mov_b32 v78, v74
    v_mov_b32 v79, v75
    ds_read_b64_tr_b16 v[162:163], v16 offset:34816
    v_permlane16_swap_b32 v72, v76
    v_permlane16_swap_b32 v73, v77
    v_permlane16_swap_b32 v74, v78
    ds_read_b64_tr_b16 v[164:165], v17 offset:32768
    v_permlane16_swap_b32 v75, v79
    v_mul_f32 v72, v19, v72
    v_mul_f32 v73, v19, v73
    ds_read_b64_tr_b16 v[166:167], v17 offset:34816
    v_mul_f32 v74, v19, v74
    v_mul_f32 v75, v19, v75
    v_mul_f32 v76, v19, v76
    ds_read_b64_tr_b16 v[168:169], v16 offset:36864
    v_mul_f32 v77, v19, v77
    v_mul_f32 v78, v19, v78
    v_mul_f32 v79, v19, v79
    ds_read_b64_tr_b16 v[170:171], v16 offset:38912
    v_pk_fma_f32 v[112:113], v[96:97], v[8:9], v[76:77] op_sel:[0,0,0] op_sel_hi:[1,0,0] neg_lo:[1,0,1] neg_hi:[1,0,1]
    v_pk_fma_f32 v[114:115], v[98:99], v[8:9], v[76:77] op_sel:[0,0,0] op_sel_hi:[1,0,0] neg_lo:[1,0,1] neg_hi:[1,0,1]
    v_pk_fma_f32 v[116:117], v[100:101], v[8:9], v[76:77] op_sel:[0,0,1] op_sel_hi:[1,0,1] neg_lo:[1,0,1] neg_hi:[1,0,1]
    ds_read_b64_tr_b16 v[172:173], v17 offset:36864
    v_pk_fma_f32 v[118:119], v[102:103], v[8:9], v[76:77] op_sel:[0,0,1] op_sel_hi:[1,0,1] neg_lo:[1,0,1] neg_hi:[1,0,1]
    v_pk_fma_f32 v[120:121], v[104:105], v[8:9], v[78:79] op_sel:[0,0,0] op_sel_hi:[1,0,0] neg_lo:[1,0,1] neg_hi:[1,0,1]
    v_pk_fma_f32 v[122:123], v[106:107], v[8:9], v[78:79] op_sel:[0,0,0] op_sel_hi:[1,0,0] neg_lo:[1,0,1] neg_hi:[1,0,1]
    ds_read_b64_tr_b16 v[174:175], v17 offset:38912
    v_pk_fma_f32 v[124:125], v[108:109], v[8:9], v[78:79] op_sel:[0,0,1] op_sel_hi:[1,0,1] neg_lo:[1,0,1] neg_hi:[1,0,1]
    v_pk_fma_f32 v[126:127], v[110:111], v[8:9], v[78:79] op_sel:[0,0,1] op_sel_hi:[1,0,1] neg_lo:[1,0,1] neg_hi:[1,0,1]
    v_pk_fma_f32 v[96:97], v[96:97], v[8:9], v[72:73] op_sel:[0,0,0] op_sel_hi:[1,0,0] neg_lo:[0,0,1] neg_hi:[0,0,1]
    ds_read_b64_tr_b16 v[176:177], v16 offset:40960
    v_pk_fma_f32 v[98:99], v[98:99], v[8:9], v[72:73] op_sel:[0,0,0] op_sel_hi:[1,0,0] neg_lo:[0,0,1] neg_hi:[0,0,1]
    v_pk_fma_f32 v[100:101], v[100:101], v[8:9], v[72:73] op_sel:[0,0,1] op_sel_hi:[1,0,1] neg_lo:[0,0,1] neg_hi:[0,0,1]
    v_pk_fma_f32 v[102:103], v[102:103], v[8:9], v[72:73] op_sel:[0,0,1] op_sel_hi:[1,0,1] neg_lo:[0,0,1] neg_hi:[0,0,1]
    ds_read_b64_tr_b16 v[178:179], v16 offset:43008
    v_pk_fma_f32 v[104:105], v[104:105], v[8:9], v[74:75] op_sel:[0,0,0] op_sel_hi:[1,0,0] neg_lo:[0,0,1] neg_hi:[0,0,1]
    v_pk_fma_f32 v[106:107], v[106:107], v[8:9], v[74:75] op_sel:[0,0,0] op_sel_hi:[1,0,0] neg_lo:[0,0,1] neg_hi:[0,0,1]
    v_pk_fma_f32 v[108:109], v[108:109], v[8:9], v[74:75] op_sel:[0,0,1] op_sel_hi:[1,0,1] neg_lo:[0,0,1] neg_hi:[0,0,1]
    ds_read_b64_tr_b16 v[180:181], v17 offset:40960
    v_pk_fma_f32 v[110:111], v[110:111], v[8:9], v[74:75] op_sel:[0,0,1] op_sel_hi:[1,0,1] neg_lo:[0,0,1] neg_hi:[0,0,1]
    v_exp_f32 v112, v112
    v_exp_f32 v113, v113
    ds_read_b64_tr_b16 v[182:183], v17 offset:43008
    v_exp_f32 v114, v114
    v_exp_f32 v115, v115
    v_exp_f32 v116, v116
    ds_read_b64_tr_b16 v[184:185], v16 offset:45056
    v_exp_f32 v117, v117
    v_exp_f32 v118, v118
    v_exp_f32 v119, v119
    ds_read_b64_tr_b16 v[186:187], v16 offset:47104
    v_exp_f32 v120, v120
    v_exp_f32 v121, v121
    v_exp_f32 v122, v122
    ds_read_b64_tr_b16 v[188:189], v17 offset:45056
    v_exp_f32 v123, v123
    v_exp_f32 v124, v124
    v_exp_f32 v125, v125
    ds_read_b64_tr_b16 v[190:191], v17 offset:47104
    v_exp_f32 v126, v126
    v_exp_f32 v127, v127
    v_exp_f32 v96, v96
    v_exp_f32 v97, v97
    v_exp_f32 v98, v98
    v_exp_f32 v99, v99
    s_cmp_ge_u32 s44, 6
    s_cbranch_scc1 Lout_18
Lback_19:
    v_exp_f32 v100, v100
    s_mov_b32 s55, 0
    buffer_load_dwordx4 v[224:227], v31, s[24:27], s55 offen sc1
    v_exp_f32 v101, v101
    v_exp_f32 v102, v102
    v_exp_f32 v103, v103
    v_exp_f32 v104, v104
    v_exp_f32 v105, v105
    v_exp_f32 v106, v106
    v_exp_f32 v107, v107
    v_exp_f32 v108, v108
    v_exp_f32 v109, v109
    v_exp_f32 v110, v110
    v_exp_f32 v111, v111
    v_pk_add_f32 v[64:65], v[112:113], v[114:115]
    v_pk_add_f32 v[66:67], v[116:117], v[118:119]
    v_pk_add_f32 v[68:69], v[120:121], v[122:123]
    s_mov_b32 s55, 4096
    buffer_load_dwordx4 v[228:231], v31, s[24:27], s55 offen sc1
    v_pk_add_f32 v[70:71], v[124:125], v[126:127]
    v_add_f32 v76, v64, v65
    v_add_f32 v77, v66, v67
    v_add_f32 v78, v68, v69
    v_add_f32 v79, v70, v71
    v_pk_add_f32 v[64:65], v[96:97], v[98:99]
    v_pk_add_f32 v[66:67], v[100:101], v[102:103]
    v_pk_add_f32 v[68:69], v[104:105], v[106:107]
    v_pk_add_f32 v[70:71], v[108:109], v[110:111]
    v_add_f32 v72, v64, v65
    v_add_f32 v73, v66, v67
    v_add_f32 v74, v68, v69
    v_add_f32 v75, v70, v71
    v_permlane16_swap_b32 v72, v76
    s_mov_b32 s55, 8192
    buffer_load_dwordx4 v[232:235], v31, s[24:27], s55 offen sc1
    v_permlane16_swap_b32 v73, v77
    v_permlane16_swap_b32 v74, v78
    v_permlane16_swap_b32 v75, v79
    v_add_f32 v72, v72, v76
    v_add_f32 v73, v73, v77
    v_add_f32 v74, v74, v78
    v_add_f32 v75, v75, v79
    v_mov_b32 v76, v72
    v_mov_b32 v77, v73
    v_mov_b32 v78, v74
    v_mov_b32 v79, v75
    v_permlane32_swap_b32 v72, v76
    v_permlane32_swap_b32 v73, v77
    v_permlane32_swap_b32 v74, v78
    s_mov_b32 s55, 12288
    buffer_load_dwordx4 v[236:239], v31, s[24:27], s55 offen sc1
    v_permlane32_swap_b32 v75, v79
    v_add_f32 v72, v72, v76
    v_add_f32 v73, v73, v77
    v_add_f32 v74, v74, v78
    v_add_f32 v75, v75, v79
    v_mov_b32 v76, v72
    v_mov_b32 v77, v73
    v_mov_b32 v78, v74
    v_mov_b32 v79, v75
    v_permlane16_swap_b32 v72, v76
    v_permlane16_swap_b32 v73, v77
    v_permlane16_swap_b32 v74, v78
    v_permlane16_swap_b32 v75, v79
    v_rcp_f32 v72, v72
    s_mov_b32 s55, 16384
    buffer_load_dwordx4 v[240:243], v31, s[24:27], s55 offen sc1
    v_rcp_f32 v73, v73
    v_rcp_f32 v74, v74
    v_rcp_f32 v75, v75
    v_rcp_f32 v76, v76
    v_rcp_f32 v77, v77
    v_rcp_f32 v78, v78
    v_rcp_f32 v79, v79
    v_pk_mul_f32 v[96:97], v[96:97], v[72:73] op_sel:[0,0] op_sel_hi:[1,0]
    v_pk_mul_f32 v[98:99], v[98:99], v[72:73] op_sel:[0,0] op_sel_hi:[1,0]
    v_pk_mul_f32 v[100:101], v[100:101], v[72:73] op_sel:[0,1] op_sel_hi:[1,1]
    v_pk_mul_f32 v[102:103], v[102:103], v[72:73] op_sel:[0,1] op_sel_hi:[1,1]
    v_pk_mul_f32 v[104:105], v[104:105], v[74:75] op_sel:[0,0] op_sel_hi:[1,0]
    v_pk_mul_f32 v[106:107], v[106:107], v[74:75] op_sel:[0,0] op_sel_hi:[1,0]
    v_pk_mul_f32 v[108:109], v[108:109], v[74:75] op_sel:[0,1] op_sel_hi:[1,1]
    s_mov_b32 s55, 20480
    buffer_load_dwordx4 v[244:247], v31, s[24:27], s55 offen sc1
    v_pk_mul_f32 v[110:111], v[110:111], v[74:75] op_sel:[0,1] op_sel_hi:[1,1]
    v_pk_mul_f32 v[112:113], v[112:113], v[76:77] op_sel:[0,0] op_sel_hi:[1,0]
    v_pk_mul_f32 v[114:115], v[114:115], v[76:77] op_sel:[0,0] op_sel_hi:[1,0]
    v_pk_mul_f32 v[116:117], v[116:117], v[76:77] op_sel:[0,1] op_sel_hi:[1,1]
    v_pk_mul_f32 v[118:119], v[118:119], v[76:77] op_sel:[0,1] op_sel_hi:[1,1]
    v_pk_mul_f32 v[120:121], v[120:121], v[78:79] op_sel:[0,0] op_sel_hi:[1,0]
    v_pk_mul_f32 v[122:123], v[122:123], v[78:79] op_sel:[0,0] op_sel_hi:[1,0]
    v_pk_mul_f32 v[124:125], v[124:125], v[78:79] op_sel:[0,1] op_sel_hi:[1,1]
    v_pk_mul_f32 v[126:127], v[126:127], v[78:79] op_sel:[0,1] op_sel_hi:[1,1]
    v_cvt_pk_bf16_f32 v32, v96, v97
    v_cvt_pk_bf16_f32 v33, v98, v99
    v_cvt_pk_bf16_f32 v34, v112, v113
    v_cvt_pk_bf16_f32 v35, v114, v115
    v_cvt_pk_bf16_f32 v36, v100, v101
    s_mov_b32 s55, 24576
    buffer_load_dwordx4 v[248:251], v31, s[24:27], s55 offen sc1
    v_cvt_pk_bf16_f32 v37, v102, v103
    v_cvt_pk_bf16_f32 v38, v116, v117
    v_cvt_pk_bf16_f32 v39, v118, v119
    v_cvt_pk_bf16_f32 v40, v104, v105
    v_cvt_pk_bf16_f32 v41, v106, v107
    v_cvt_pk_bf16_f32 v42, v120, v121
    v_cvt_pk_bf16_f32 v43, v122, v123
    v_cvt_pk_bf16_f32 v44, v108, v109
    v_cvt_pk_bf16_f32 v45, v110, v111
    v_cvt_pk_bf16_f32 v46, v124, v125
    v_cvt_pk_bf16_f32 v47, v126, v127
    s_mov_b32 s55, 28672
    buffer_load_dwordx4 v[252:255], v31, s[24:27], s55 offen sc1
    v_mov_b32 v26, 0x3f80
    v_mov_b32 v27, 0x3f800000
    s_waitcnt vmcnt(0)
    v_max3_u32 v56, v224, v225, v226
    v_max3_u32 v56, v56, v227, v228
    v_max3_u32 v56, v56, v229, v230
    v_max3_u32 v56, v56, v231, v232
    v_max3_u32 v56, v56, v233, v234
    v_max3_u32 v56, v56, v235, v236
    v_max3_u32 v56, v56, v237, v238
    v_max3_u32 v56, v56, v239, v240
    v_max3_u32 v56, v56, v241, v242
    v_max3_u32 v56, v56, v243, v244
    v_max3_u32 v56, v56, v245, v246
    v_max3_u32 v56, v56, v247, v248
    v_max3_u32 v56, v56, v249, v250
    v_max3_u32 v56, v56, v251, v252
    v_max3_u32 v56, v56, v253, v254
    v_max_u32 v56, v56, v255
    v_cmp_eq_u32 vcc, -1, v56
    s_cbranch_vccnz Lgr_20
Lgo_21:
    v_dot2_f32_bf16 v48, v224, v26, 0
    v_dot2_f32_bf16 v49, v224, v27, 0
    v_dot2_f32_bf16 v50, v225, v26, 0
    v_dot2_f32_bf16 v51, v225, v27, 0
    v_dot2_f32_bf16 v52, v226, v26, 0
    v_dot2_f32_bf16 v53, v226, v27, 0
    v_dot2_f32_bf16 v54, v227, v26, 0
    v_dot2_f32_bf16 v55, v227, v27, 0
    v_dot2_f32_bf16 v48, v228, v26, v48
    v_dot2_f32_bf16 v49, v228, v27, v49
    v_dot2_f32_bf16 v50, v229, v26, v50
    v_dot2_f32_bf16 v51, v229, v27, v51
    v_dot2_f32_bf16 v52, v230, v26, v52
    v_dot2_f32_bf16 v53, v230, v27, v53
    v_dot2_f32_bf16 v54, v231, v26, v54
    v_dot2_f32_bf16 v55, v231, v27, v55
    v_dot2_f32_bf16 v48, v232, v26, v48
    v_dot2_f32_bf16 v49, v232, v27, v49
    v_dot2_f32_bf16 v50, v233, v26, v50
    v_dot2_f32_bf16 v51, v233, v27, v51
    v_dot2_f32_bf16 v52, v234, v26, v52
    v_dot2_f32_bf16 v53, v234, v27, v53
    v_dot2_f32_bf16 v54, v235, v26, v54
    v_dot2_f32_bf16 v55, v235, v27, v55
    v_dot2_f32_bf16 v48, v236, v26, v48
    v_dot2_f32_bf16 v49, v236, v27, v49
    v_dot2_f32_bf16 v50, v237, v26, v50
    v_dot2_f32_bf16 v51, v237, v27, v51
    v_dot2_f32_bf16 v52, v238, v26, v52
    v_dot2_f32_bf16 v53, v238, v27, v53
    v_dot2_f32_bf16 v54, v239, v26, v54
    v_dot2_f32_bf16 v55, v239, v27, v55
    v_dot2_f32_bf16 v48, v240, v26, v48
    v_dot2_f32_bf16 v49, v240, v27, v49
    v_dot2_f32_bf16 v50, v241, v26, v50
    v_dot2_f32_bf16 v51, v241, v27, v51
    v_dot2_f32_bf16 v52, v242, v26, v52
    v_dot2_f32_bf16 v53, v242, v27, v53
    v_dot2_f32_bf16 v54, v243, v26, v54
    v_dot2_f32_bf16 v55, v243, v27, v55
    v_dot2_f32_bf16 v48, v244, v26, v48
    v_dot2_f32_bf16 v49, v244, v27, v49
    v_dot2_f32_bf16 v50, v245, v26, v50
    v_dot2_f32_bf16 v51, v245, v27, v51
    v_dot2_f32_bf16 v52, v246, v26, v52
    v_dot2_f32_bf16 v53, v246, v27, v53
    v_dot2_f32_bf16 v54, v247, v26, v54
    v_dot2_f32_bf16 v55, v247, v27, v55
    v_dot2_f32_bf16 v48, v248, v26, v48
    v_dot2_f32_bf16 v49, v248, v27, v49
    v_dot2_f32_bf16 v50, v249, v26, v50
    v_dot2_f32_bf16 v51, v249, v27, v51
    v_dot2_f32_bf16 v52, v250, v26, v52
    v_dot2_f32_bf16 v53, v250, v27, v53
    v_dot2_f32_bf16 v54, v251, v26, v54
    v_dot2_f32_bf16 v55, v251, v27, v55
    v_dot2_f32_bf16 v48, v252, v26, v48
    v_dot2_f32_bf16 v49, v252, v27, v49
    v_dot2_f32_bf16 v50, v253, v26, v50
    v_dot2_f32_bf16 v51, v253, v27, v51
    v_dot2_f32_bf16 v52, v254, v26, v52
    v_dot2_f32_bf16 v53, v254, v27, v53
    v_dot2_f32_bf16 v54, v255, v26, v54
    v_dot2_f32_bf16 v55, v255, v27, v55
    s_lshl_b32 s54, s44, 11
    s_add_u32 s54, s54, 0x20000
    v_add_u32 v30, s54, v18
    ds_write_b128 v30, v[48:51] offset:0
    ds_write_b128 v30, v[52:55] offset:1024
    s_cmp_ge_u32 s44, 6
    s_cbranch_scc1 Lout_23
Lback_24:
    s_waitcnt vmcnt(8)
    s_waitcnt lgkmcnt(0)
    s_barrier
    s_cmp_eq_u32 s44, 5
    s_cbranch_scc1 Lout_27
Lback_28:
    s_lshl_b32 s54, s45, 13
    s_add_u32 s54, s54, 0x20000
    v_add_u32 v30, s54, v18
    ds_read_b128 v[64:67], v30 offset:0
    ds_read_b128 v[68:71], v30 offset:2048
    ds_read_b128 v[72:75], v30 offset:1024
    ds_read_b128 v[76:79], v30 offset:3072
    ds_read_b128 v[80:83], v30 offset:4096
    ds_read_b128 v[84:87], v30 offset:6144
    ds_read_b128 v[88:91], v30 offset:5120
    ds_read_b128 v[92:95], v30 offset:7168
    v_lshrrev_b32 v31, 4, v0
    v_lshlrev_b32 v31, 4, v31
    s_lshl_b32 s54, s45, 8
    s_add_u32 s54, s54, 0x24000
    v_add_u32 v31, s54, v31
    ds_read_b128 v[48:51], v31 offset:0
    ds_read_b128 v[52:55], v31 offset:512
    ds_read_b128 v[56:59], v31 offset:64
    ds_read_b128 v[60:63], v31 offset:576
    ds_read_b128 v[112:115], v31 offset:128
    ds_read_b128 v[116:119], v31 offset:640
    ds_read_b128 v[120:123], v31 offset:192
    ds_read_b128 v[124:127], v31 offset:704
    s_waitcnt lgkmcnt(8)
    v_add_f32 v64, v64, v68
    v_add_f32 v65, v65, v69
    v_add_f32 v66, v66, v70
    v_add_f32 v67, v67, v71
    v_add_f32 v72, v72, v76
    v_add_f32 v73, v73, v77
    v_add_f32 v74, v74, v78
    v_add_f32 v75, v75, v79
    v_add_f32 v80, v80, v84
    v_add_f32 v81, v81, v85
    v_add_f32 v82, v82, v86
    v_add_f32 v83, v83, v87
    v_add_f32 v88, v88, v92
    v_add_f32 v89, v89, v93
    v_add_f32 v90, v90, v94
    v_add_f32 v91, v91, v95
    v_cvt_pk_bf16_f32 v96, v64, v65
    v_cvt_pk_bf16_f32 v97, v66, v67
    v_cvt_pk_bf16_f32 v98, v72, v73
    v_cvt_pk_bf16_f32 v99, v74, v75
    v_cvt_pk_bf16_f32 v100, v80, v81
    v_cvt_pk_bf16_f32 v101, v82, v83
    v_cvt_pk_bf16_f32 v102, v88, v89
    v_cvt_pk_bf16_f32 v103, v90, v91
    s_waitcnt lgkmcnt(0)
    v_add_f32 v48, v48, v52
    v_add_f32 v49, v49, v53
    v_add_f32 v50, v50, v54
    v_add_f32 v51, v51, v55
    v_add_f32 v56, v56, v60
    v_add_f32 v57, v57, v61
    v_add_f32 v58, v58, v62
    v_add_f32 v59, v59, v63
    v_add_f32 v112, v112, v116
    v_add_f32 v113, v113, v117
    v_add_f32 v114, v114, v118
    v_add_f32 v115, v115, v119
    v_add_f32 v120, v120, v124
    v_add_f32 v121, v121, v125
    v_add_f32 v122, v122, v126
    v_add_f32 v123, v123, v127
    v_cvt_pk_bf16_f32 v104, v48, v49
    v_cvt_pk_bf16_f32 v105, v50, v51
    v_cvt_pk_bf16_f32 v106, v56, v57
    v_cvt_pk_bf16_f32 v107, v58, v59
    v_cvt_pk_bf16_f32 v108, v112, v113
    v_cvt_pk_bf16_f32 v109, v114, v115
    v_cvt_pk_bf16_f32 v110, v120, v121
    v_cvt_pk_bf16_f32 v111, v122, v123
    v_mfma_f32_16x16x32_bf16 v[80:83], v[104:107], v[32:35], 0
    v_mfma_f32_16x16x32_bf16 v[84:87], v[104:107], v[36:39], 0
    v_mfma_f32_16x16x32_bf16 v[88:91], v[108:111], v[40:43], 0
    v_mfma_f32_16x16x32_bf16 v[92:95], v[108:111], v[44:47], 0
    v_mfma_f32_16x16x32_bf16 v[64:67], v[96:99], v[32:35], 0
    v_mfma_f32_16x16x32_bf16 v[68:71], v[96:99], v[36:39], 0
    v_mfma_f32_16x16x32_bf16 v[72:75], v[100:103], v[40:43], 0
    v_mfma_f32_16x16x32_bf16 v[76:79], v[100:103], v[44:47], 0
    s_nop 0
    v_add_f32 v80, 0x358637bd, v80
    v_add_f32 v84, 0x358637bd, v84
    v_add_f32 v88, 0x358637bd, v88
    v_add_f32 v92, 0x358637bd, v92
    v_rcp_f32 v80, v80
    v_rcp_f32 v84, v84
    v_rcp_f32 v88, v88
    v_rcp_f32 v92, v92
    v_mul_f32 v64, v64, v80
    v_mul_f32 v65, v65, v80
    v_mul_f32 v66, v66, v80
    v_mul_f32 v67, v67, v80
    v_mul_f32 v68, v68, v84
    v_mul_f32 v69, v69, v84
    v_mul_f32 v70, v70, v84
    v_mul_f32 v71, v71, v84
    v_mul_f32 v72, v72, v88
    v_mul_f32 v73, v73, v88
    v_mul_f32 v74, v74, v88
    v_mul_f32 v75, v75, v88
    v_mul_f32 v76, v76, v92
    v_mul_f32 v77, v77, v92
    v_mul_f32 v78, v78, v92
    v_mul_f32 v79, v79, v92
    v_cvt_pk_bf16_f32 v112, v64, v65
    v_cvt_pk_bf16_f32 v113, v66, v67
    v_cvt_pk_bf16_f32 v116, v68, v69
    v_cvt_pk_bf16_f32 v117, v70, v71
    v_cvt_pk_bf16_f32 v114, v72, v73
    v_cvt_pk_bf16_f32 v115, v74, v75
    v_cvt_pk_bf16_f32 v118, v76, v77
    v_cvt_pk_bf16_f32 v119, v78, v79
    s_mov_b32 s55, 0x8000
    buffer_store_dwordx4 v[112:115], v12, s[24:27], 0 offen sc1
    buffer_store_dwordx4 v[116:119], v12, s[24:27], s55 offen sc1
    s_barrier
    s_cmp_eq_u32 s44, 5
    s_cbranch_scc1 Lout_29
Lback_30:
    s_add_u32 m0, s76, 98304
    s_nop 0
    buffer_load_dwordx4 v6, s[16:19], s83 offen lds
    s_add_u32 m0, s76, 99328
    s_nop 0
    buffer_load_dwordx4 v7, s[16:19], s83 offen lds
    s_add_u32 m0, s76, 114688
    s_nop 0
    buffer_load_dwordx4 v6, s[20:23], s83 offen lds
    s_add_u32 m0, s76, 115712
    s_nop 0
    buffer_load_dwordx4 v7, s[20:23], s83 offen lds
    s_branch L_p3
L_type1:
    s_cmp_lg_u32 s45, 1
    s_cbranch_scc1 Lpr_31
    s_setprio 1
Lpr_31:
    s_waitcnt vmcnt(8)
    s_barrier
    ds_read_b128 v[128:131], v8 offset:0
    ds_read_b128 v[132:135], v8 offset:2048
    ds_read_b64_tr_b16 v[64:65], v10 offset:0
    ds_read_b64_tr_b16 v[66:67], v10 offset:1024
    ds_read_b64_tr_b16 v[68:69], v11 offset:0
    ds_read_b64_tr_b16 v[70:71], v11 offset:1024
    ds_read_b64_tr_b16 v[72:73], v12 offset:0
    ds_read_b64_tr_b16 v[74:75], v12 offset:1024
    ds_read_b64_tr_b16 v[76:77], v13 offset:0
    ds_read_b64_tr_b16 v[78:79], v13 offset:1024
    s_waitcnt lgkmcnt(6)
    v_mfma_f32_16x16x32_bf16 v[96:99], v[64:67], v[128:131], 0
    ds_read_b128 v[136:139], v9 offset:0
    v_mfma_f32_16x16x32_bf16 v[100:103], v[64:67], v[132:135], 0
    ds_read_b128 v[140:143], v9 offset:2048
    s_add_u32 m0, s76, 65536
    s_nop 0
    buffer_load_dwordx4 v1, s[4:7], s62 offen lds
    s_waitcnt lgkmcnt(6)
    v_mfma_f32_16x16x32_bf16 v[104:107], v[68:71], v[128:131], 0
    ds_read_b64_tr_b16 v[80:81], v10 offset:8192
    v_mfma_f32_16x16x32_bf16 v[108:111], v[68:71], v[132:135], 0
    ds_read_b64_tr_b16 v[82:83], v10 offset:9216
    s_add_u32 m0, s76, 81920
    s_nop 0
    buffer_load_dwordx4 v3, s[8:11], s70 offen lds
    s_waitcnt lgkmcnt(6)
    v_mfma_f32_16x16x32_bf16 v[112:115], v[128:131], v[72:75], 0
    ds_read_b64_tr_b16 v[84:85], v11 offset:8192
    v_mfma_f32_16x16x32_bf16 v[116:119], v[132:135], v[72:75], 0
    ds_read_b64_tr_b16 v[86:87], v11 offset:9216
    s_add_u32 m0, s76, 66560
    s_nop 0
    buffer_load_dwordx4 v2, s[4:7], s62 offen lds
    s_waitcnt lgkmcnt(6)
    v_mfma_f32_16x16x32_bf16 v[120:123], v[128:131], v[76:79], 0
    ds_read_b64_tr_b16 v[88:89], v12 offset:8192
    ds_read_b64_tr_b16 v[90:91], v12 offset:9216
    v_mfma_f32_16x16x32_bf16 v[124:127], v[132:135], v[76:79], 0
    ds_read_b64_tr_b16 v[92:93], v13 offset:8192
    ds_read_b64_tr_b16 v[94:95], v13 offset:9216
    s_add_u32 m0, s76, 82944
    s_nop 0
    buffer_load_dwordx4 v4, s[8:11], s70 offen lds
    s_waitcnt lgkmcnt(6)
    v_mfma_f32_16x16x32_bf16 v[96:99], v[80:83], v[136:139], v[96:99]
    s_waitcnt vmcnt(8)
    s_barrier
    v_add_u32 v8, 0x8000, v8
    v_add_u32 v9, 0x8000, v9
    v_add_u32 v10, 0x8000, v10
    v_add_u32 v11, 0x8000, v11
    v_add_u32 v12, 0x8000, v12
    v_add_u32 v13, 0x8000, v13
    ds_read_b128 v[144:147], v8 offset:0
    v_mfma_f32_16x16x32_bf16 v[100:103], v[80:83], v[140:143], v[100:103]
    ds_read_b128 v[148:151], v8 offset:2048
    s_waitcnt lgkmcnt(6)
    v_mfma_f32_16x16x32_bf16 v[104:107], v[84:87], v[136:139], v[104:107]
    ds_read_b64_tr_b16 v[64:65], v10 offset:0
    v_mfma_f32_16x16x32_bf16 v[108:111], v[84:87], v[140:143], v[108:111]
    ds_read_b64_tr_b16 v[66:67], v10 offset:1024
    s_add_u32 m0, s76, 98304
    s_nop 0
    buffer_load_dwordx4 v1, s[4:7], s63 offen lds
    s_waitcnt lgkmcnt(6)
    v_mfma_f32_16x16x32_bf16 v[112:115], v[136:139], v[88:91], v[112:115]
    ds_read_b64_tr_b16 v[68:69], v11 offset:0
    v_mfma_f32_16x16x32_bf16 v[116:119], v[140:143], v[88:91], v[116:119]
    ds_read_b64_tr_b16 v[70:71], v11 offset:1024
    s_waitcnt lgkmcnt(6)
    v_mfma_f32_16x16x32_bf16 v[120:123], v[136:139], v[92:95], v[120:123]
    ds_read_b64_tr_b16 v[72:73], v12 offset:0
    ds_read_b64_tr_b16 v[74:75], v12 offset:1024
    s_add_u32 m0, s76, 114688
    s_nop 0
    buffer_load_dwordx4 v3, s[8:11], s71 offen lds
    v_mfma_f32_16x16x32_bf16 v[124:127], v[140:143], v[92:95], v[124:127]
    ds_read_b64_tr_b16 v[76:77], v13 offset:0
    ds_read_b64_tr_b16 v[78:79], v13 offset:1024
    s_waitcnt lgkmcnt(6)
    v_mfma_f32_16x16x32_bf16 v[96:99], v[64:67], v[144:147], v[96:99]
    ds_read_b128 v[152:155], v9 offset:0
    v_mfma_f32_16x16x32_bf16 v[100:103], v[64:67], v[148:151], v[100:103]
    ds_read_b128 v[156:159], v9 offset:2048
    s_waitcnt lgkmcnt(6)
    v_mfma_f32_16x16x32_bf16 v[104:107], v[68:71], v[144:147], v[104:107]
    ds_read_b64_tr_b16 v[80:81], v10 offset:8192
    s_add_u32 m0, s76, 99328
    s_nop 0
    buffer_load_dwordx4 v2, s[4:7], s63 offen lds
    v_mfma_f32_16x16x32_bf16 v[108:111], v[68:71], v[148:151], v[108:111]
    ds_read_b64_tr_b16 v[82:83], v10 offset:9216
    s_waitcnt lgkmcnt(6)
    v_mfma_f32_16x16x32_bf16 v[112:115], v[144:147], v[72:75], v[112:115]
    ds_read_b64_tr_b16 v[84:85], v11 offset:8192
    v_mfma_f32_16x16x32_bf16 v[116:119], v[148:151], v[72:75], v[116:119]
    ds_read_b64_tr_b16 v[86:87], v11 offset:9216
    s_waitcnt lgkmcnt(6)
    v_mfma_f32_16x16x32_bf16 v[120:123], v[144:147], v[76:79], v[120:123]
    ds_read_b64_tr_b16 v[88:89], v12 offset:8192
    ds_read_b64_tr_b16 v[90:91], v12 offset:9216
    s_add_u32 m0, s76, 115712
    s_nop 0
    buffer_load_dwordx4 v4, s[8:11], s71 offen lds
    v_mfma_f32_16x16x32_bf16 v[124:127], v[148:151], v[76:79], v[124:127]
    ds_read_b64_tr_b16 v[92:93], v13 offset:8192
    ds_read_b64_tr_b16 v[94:95], v13 offset:9216
    s_waitcnt lgkmcnt(6)
    v_mfma_f32_16x16x32_bf16 v[96:99], v[80:83], v[152:155], v[96:99]
    s_waitcnt vmcnt(4)
    s_barrier
    v_add_u32 v8, 0x8000, v8
    v_add_u32 v9, 0x8000, v9
    v_add_u32 v10, 0x8000, v10
    v_add_u32 v11, 0x8000, v11
    v_add_u32 v12, 0x8000, v12
    v_add_u32 v13, 0x8000, v13
    s_waitcnt vmcnt(8)
    v_readfirstlane_b32 s50, v48
    v_readfirstlane_b32 s51, v49
    s_nop 1
    s_add_u32 s50, s50, 1
    s_xor_b32 s51, s51, 0x9e3779b9
    s_cmp_eq_u32 s44, 5
    s_cbranch_scc1 Lout_32
Lback_33:
    ds_read_b128 v[160:163], v8 offset:0
    v_mfma_f32_16x16x32_bf16 v[100:103], v[80:83], v[156:159], v[100:103]
    ds_read_b128 v[164:167], v8 offset:2048
    s_waitcnt lgkmcnt(6)
    v_mfma_f32_16x16x32_bf16 v[104:107], v[84:87], v[152:155], v[104:107]
    ds_read_b64_tr_b16 v[64:65], v10 offset:0
    v_mfma_f32_16x16x32_bf16 v[108:111], v[84:87], v[156:159], v[108:111]
    ds_read_b64_tr_b16 v[66:67], v10 offset:1024
    s_add_u32 m0, s76, 131072
    s_nop 0
    buffer_load_dwordx4 v1, s[4:7], s64 offen lds
    s_waitcnt lgkmcnt(6)
    v_mfma_f32_16x16x32_bf16 v[112:115], v[152:155], v[88:91], v[112:115]
    ds_read_b64_tr_b16 v[68:69], v11 offset:0
    v_mfma_f32_16x16x32_bf16 v[116:119], v[156:159], v[88:91], v[116:119]
    ds_read_b64_tr_b16 v[70:71], v11 offset:1024
    s_waitcnt lgkmcnt(6)
    v_mfma_f32_16x16x32_bf16 v[120:123], v[152:155], v[92:95], v[120:123]
    ds_read_b64_tr_b16 v[72:73], v12 offset:0
    ds_read_b64_tr_b16 v[74:75], v12 offset:1024
    s_add_u32 m0, s76, 147456
    s_nop 0
    buffer_load_dwordx4 v3, s[8:11], s72 offen lds
    v_mfma_f32_16x16x32_bf16 v[124:127], v[156:159], v[92:95], v[124:127]
    ds_read_b64_tr_b16 v[76:77], v13 offset:0
    ds_read_b64_tr_b16 v[78:79], v13 offset:1024
    s_waitcnt vmcnt(11)
    v_mfma_f32_16x16x16_bf16 v[36:39], v[32:33], v[20:21], 0
    v_mfma_f32_16x16x16_bf16 v[40:43], v[34:35], v[20:21], 0
    s_waitcnt lgkmcnt(6)
    v_mfma_f32_16x16x32_bf16 v[96:99], v[64:67], v[160:163], v[96:99]
    ds_read_b128 v[168:171], v9 offset:0
    v_mfma_f32_16x16x32_bf16 v[100:103], v[64:67], v[164:167], v[100:103]
    ds_read_b128 v[172:175], v9 offset:2048
    s_waitcnt lgkmcnt(6)
    v_mfma_f32_16x16x32_bf16 v[104:107], v[68:71], v[160:163], v[104:107]
    ds_read_b64_tr_b16 v[80:81], v10 offset:8192
    s_add_u32 m0, s76, 132096
    s_nop 0
    buffer_load_dwordx4 v2, s[4:7], s64 offen lds
    v_mfma_f32_16x16x32_bf16 v[108:111], v[68:71], v[164:167], v[108:111]
    ds_read_b64_tr_b16 v[82:83], v10 offset:9216
    s_waitcnt lgkmcnt(6)
    v_mfma_f32_16x16x32_bf16 v[112:115], v[160:163], v[72:75], v[112:115]
    ds_read_b64_tr_b16 v[84:85], v11 offset:8192
    v_mfma_f32_16x16x32_bf16 v[116:119], v[164:167], v[72:75], v[116:119]
    ds_read_b64_tr_b16 v[86:87], v11 offset:9216
    s_waitcnt lgkmcnt(6)
    v_mfma_f32_16x16x32_bf16 v[120:123], v[160:163], v[76:79], v[120:123]
    ds_read_b64_tr_b16 v[88:89], v12 offset:8192
    ds_read_b64_tr_b16 v[90:91], v12 offset:9216
    s_add_u32 m0, s76, 148480
    s_nop 0
    buffer_load_dwordx4 v4, s[8:11], s72 offen lds
    v_mfma_f32_16x16x32_bf16 v[124:127], v[164:167], v[76:79], v[124:127]
    ds_read_b64_tr_b16 v[92:93], v13 offset:8192
    ds_read_b64_tr_b16 v[94:95], v13 offset:9216
    s_waitcnt lgkmcnt(6)
    v_mfma_f32_16x16x32_bf16 v[96:99], v[80:83], v[168:171], v[96:99]
    s_waitcnt vmcnt(4)
    s_barrier
    v_add_u32 v8, 0x8000, v8
    v_add_u32 v9, 0x8000, v9
    v_add_u32 v10, 0x8000, v10
    v_add_u32 v11, 0x8000, v11
    v_add_u32 v12, 0x8000, v12
    v_add_u32 v13, 0x8000, v13
    ds_read_b128 v[176:179], v8 offset:0
    v_mfma_f32_16x16x32_bf16 v[100:103], v[80:83], v[172:175], v[100:103]
    ds_read_b128 v[180:183], v8 offset:2048
    s_waitcnt lgkmcnt(6)
    v_mfma_f32_16x16x32_bf16 v[104:107], v[84:87], v[168:171], v[104:107]
    ds_read_b64_tr_b16 v[64:65], v10 offset:0
    v_mfma_f32_16x16x32_bf16 v[108:111], v[84:87], v[172:175], v[108:111]
    ds_read_b64_tr_b16 v[66:67], v10 offset:1024
    s_add_u32 m0, s76, 0
    s_nop 0
    buffer_load_dwordx4 v1, s[4:7], s65 offen lds
    s_waitcnt lgkmcnt(6)
    v_mfma_f32_16x16x32_bf16 v[112:115], v[168:171], v[88:91], v[112:115]
    ds_read_b64_tr_b16 v[68:69], v11 offset:0
    v_mfma_f32_16x16x32_bf16 v[116:119], v[172:175], v[88:91], v[116:119]
    ds_read_b64_tr_b16 v[70:71], v11 offset:1024
    s_waitcnt lgkmcnt(6)
    v_mfma_f32_16x16x32_bf16 v[120:123], v[168:171], v[92:95], v[120:123]
    ds_read_b64_tr_b16 v[72:73], v12 offset:0
    ds_read_b64_tr_b16 v[74:75], v12 offset:1024
    s_add_u32 m0, s76, 16384
    s_nop 0
    buffer_load_dwordx4 v3, s[8:11], s73 offen lds
    v_mfma_f32_16x16x32_bf16 v[124:127], v[172:175], v[92:95], v[124:127]
    ds_read_b64_tr_b16 v[76:77], v13 offset:0
    ds_read_b64_tr_b16 v[78:79], v13 offset:1024
    v_cvt_pk_bf16_f32 v22, v36, v37
    v_cvt_pk_bf16_f32 v23, v38, v39
    v_cvt_pk_bf16_f32 v24, v40, v41
    v_cvt_pk_bf16_f32 v25, v42, v43
    s_waitcnt lgkmcnt(6)
    v_mfma_f32_16x16x32_bf16 v[96:99], v[64:67], v[176:179], v[96:99]
    ds_read_b128 v[184:187], v9 offset:0
    v_mfma_f32_16x16x32_bf16 v[100:103], v[64:67], v[180:183], v[100:103]
    ds_read_b128 v[188:191], v9 offset:2048
    s_waitcnt lgkmcnt(6)
    v_mfma_f32_16x16x32_bf16 v[104:107], v[68:71], v[176:179], v[104:107]
    ds_read_b64_tr_b16 v[80:81], v10 offset:8192
    s_add_u32 m0, s76, 1024
    s_nop 0
    buffer_load_dwordx4 v2, s[4:7], s65 offen lds
    v_mfma_f32_16x16x32_bf16 v[108:111], v[68:71], v[180:183], v[108:111]
    ds_read_b64_tr_b16 v[82:83], v10 offset:9216
    s_waitcnt lgkmcnt(6)
    v_mfma_f32_16x16x32_bf16 v[112:115], v[176:179], v[72:75], v[112:115]
    ds_read_b64_tr_b16 v[84:85], v11 offset:8192
    v_mfma_f32_16x16x32_bf16 v[116:119], v[180:183], v[72:75], v[116:119]
    ds_read_b64_tr_b16 v[86:87], v11 offset:9216
    s_waitcnt lgkmcnt(6)
    v_mfma_f32_16x16x32_bf16 v[120:123], v[176:179], v[76:79], v[120:123]
    ds_read_b64_tr_b16 v[88:89], v12 offset:8192
    ds_read_b64_tr_b16 v[90:91], v12 offset:9216
    s_add_u32 m0, s76, 17408
    s_nop 0
    buffer_load_dwordx4 v4, s[8:11], s73 offen lds
    v_mfma_f32_16x16x32_bf16 v[124:127], v[180:183], v[76:79], v[124:127]
    ds_read_b64_tr_b16 v[92:93], v13 offset:8192
    ds_read_b64_tr_b16 v[94:95], v13 offset:9216
    s_waitcnt lgkmcnt(6)
    v_mfma_f32_16x16x32_bf16 v[96:99], v[80:83], v[184:187], v[96:99]
    s_waitcnt vmcnt(4)
    s_barrier
    v_add_u32 v8, 0x8000, v8
    v_add_u32 v9, 0x8000, v9
    v_add_u32 v10, 0x8000, v10
    v_add_u32 v11, 0x8000, v11
    v_add_u32 v12, 0x8000, v12
    v_add_u32 v13, 0x8000, v13
    ds_read_b128 v[192:195], v8 offset:0
    v_mfma_f32_16x16x32_bf16 v[100:103], v[80:83], v[188:191], v[100:103]
    ds_read_b128 v[196:199], v8 offset:2048
    s_waitcnt lgkmcnt(6)
    v_mfma_f32_16x16x32_bf16 v[104:107], v[84:87], v[184:187], v[104:107]
    ds_read_b64_tr_b16 v[64:65], v10 offset:0
    v_mfma_f32_16x16x32_bf16 v[108:111], v[84:87], v[188:191], v[108:111]
    ds_read_b64_tr_b16 v[66:67], v10 offset:1024
    s_add_u32 m0, s76, 32768
    s_nop 0
    buffer_load_dwordx4 v1, s[4:7], s66 offen lds
    s_waitcnt lgkmcnt(6)
    v_mfma_f32_16x16x32_bf16 v[112:115], v[184:187], v[88:91], v[112:115]
    ds_read_b64_tr_b16 v[68:69], v11 offset:0
    v_mfma_f32_16x16x32_bf16 v[116:119], v[188:191], v[88:91], v[116:119]
    ds_read_b64_tr_b16 v[70:71], v11 offset:1024
    s_waitcnt lgkmcnt(6)
    v_mfma_f32_16x16x32_bf16 v[120:123], v[184:187], v[92:95], v[120:123]
    ds_read_b64_tr_b16 v[72:73], v12 offset:0
    ds_read_b64_tr_b16 v[74:75], v12 offset:1024
    s_add_u32 m0, s76, 49152
    s_nop 0
    buffer_load_dwordx4 v3, s[8:11], s74 offen lds
    v_mfma_f32_16x16x32_bf16 v[124:127], v[188:191], v[92:95], v[124:127]
    ds_read_b64_tr_b16 v[76:77], v13 offset:0
    ds_read_b64_tr_b16 v[78:79], v13 offset:1024
    s_waitcnt lgkmcnt(6)
    v_mfma_f32_16x16x32_bf16 v[96:99], v[64:67], v[192:195], v[96:99]
    ds_read_b128 v[200:203], v9 offset:0
    v_mfma_f32_16x16x32_bf16 v[100:103], v[64:67], v[196:199], v[100:103]
    ds_read_b128 v[204:207], v9 offset:2048
    s_waitcnt lgkmcnt(6)
    v_mfma_f32_16x16x32_bf16 v[104:107], v[68:71], v[192:195], v[104:107]
    ds_read_b64_tr_b16 v[80:81], v10 offset:8192
    s_add_u32 m0, s76, 33792
    s_nop 0
    buffer_load_dwordx4 v2, s[4:7], s66 offen lds
    v_mfma_f32_16x16x32_bf16 v[108:111], v[68:71], v[196:199], v[108:111]
    ds_read_b64_tr_b16 v[82:83], v10 offset:9216
    s_waitcnt lgkmcnt(6)
    v_mfma_f32_16x16x32_bf16 v[112:115], v[192:195], v[72:75], v[112:115]
    ds_read_b64_tr_b16 v[84:85], v11 offset:8192
    v_mfma_f32_16x16x32_bf16 v[116:119], v[196:199], v[72:75], v[116:119]
    ds_read_b64_tr_b16 v[86:87], v11 offset:9216
    s_waitcnt lgkmcnt(6)
    v_mfma_f32_16x16x32_bf16 v[120:123], v[192:195], v[76:79], v[120:123]
    ds_read_b64_tr_b16 v[88:89], v12 offset:8192
    ds_read_b64_tr_b16 v[90:91], v12 offset:9216
    s_add_u32 m0, s76, 50176
    s_nop 0
    buffer_load_dwordx4 v4, s[8:11], s74 offen lds
    v_mfma_f32_16x16x32_bf16 v[124:127], v[196:199], v[76:79], v[124:127]
    ds_read_b64_tr_b16 v[92:93], v13 offset:8192
    ds_read_b64_tr_b16 v[94:95], v13 offset:9216
    s_waitcnt lgkmcnt(6)
    v_mfma_f32_16x16x32_bf16 v[96:99], v[80:83], v[200:203], v[96:99]
    s_waitcnt vmcnt(4)
    s_barrier
    v_subrev_u32 v8, 0x20000, v8
    v_subrev_u32 v9, 0x20000, v9
    v_subrev_u32 v10, 0x20000, v10
    v_subrev_u32 v11, 0x20000, v11
    v_subrev_u32 v12, 0x20000, v12
    v_subrev_u32 v13, 0x20000, v13
    ds_read_b128 v[208:211], v8 offset:0
    v_mfma_f32_16x16x32_bf16 v[100:103], v[80:83], v[204:207], v[100:103]
    ds_read_b128 v[212:215], v8 offset:2048
    s_waitcnt lgkmcnt(6)
    v_mfma_f32_16x16x32_bf16 v[104:107], v[84:87], v[200:203], v[104:107]
    ds_read_b64_tr_b16 v[64:65], v10 offset:0
    v_mfma_f32_16x16x32_bf16 v[108:111], v[84:87], v[204:207], v[108:111]
    ds_read_b64_tr_b16 v[66:67], v10 offset:1024
    s_add_u32 m0, s76, 65536
    s_nop 0
    buffer_load_dwordx4 v1, s[4:7], s67 offen lds
    s_waitcnt lgkmcnt(6)
    v_mfma_f32_16x16x32_bf16 v[112:115], v[200:203], v[88:91], v[112:115]
    ds_read_b64_tr_b16 v[68:69], v11 offset:0
    v_mfma_f32_16x16x32_bf16 v[116:119], v[204:207], v[88:91], v[116:119]
    ds_read_b64_tr_b16 v[70:71], v11 offset:1024
    s_waitcnt lgkmcnt(6)
    v_mfma_f32_16x16x32_bf16 v[120:123], v[200:203], v[92:95], v[120:123]
    ds_read_b64_tr_b16 v[72:73], v12 offset:0
    ds_read_b64_tr_b16 v[74:75], v12 offset:1024
    s_add_u32 m0, s76, 81920
    s_nop 0
    buffer_load_dwordx4 v3, s[8:11], s75 offen lds
    v_mfma_f32_16x16x32_bf16 v[124:127], v[204:207], v[92:95], v[124:127]
    ds_read_b64_tr_b16 v[76:77], v13 offset:0
    ds_read_b64_tr_b16 v[78:79], v13 offset:1024
    s_waitcnt lgkmcnt(6)
    v_mfma_f32_16x16x32_bf16 v[96:99], v[64:67], v[208:211], v[96:99]
    ds_read_b128 v[216:219], v9 offset:0
    v_mfma_f32_16x16x32_bf16 v[100:103], v[64:67], v[212:215], v[100:103]
    ds_read_b128 v[220:223], v9 offset:2048
    s_waitcnt lgkmcnt(6)
    v_mfma_f32_16x16x32_bf16 v[104:107], v[68:71], v[208:211], v[104:107]
    ds_read_b64_tr_b16 v[80:81], v10 offset:8192
    s_add_u32 m0, s76, 66560
    s_nop 0
    buffer_load_dwordx4 v2, s[4:7], s67 offen lds
    v_mfma_f32_16x16x32_bf16 v[108:111], v[68:71], v[212:215], v[108:111]
    ds_read_b64_tr_b16 v[82:83], v10 offset:9216
    s_waitcnt lgkmcnt(6)
    v_mfma_f32_16x16x32_bf16 v[112:115], v[208:211], v[72:75], v[112:115]
    ds_read_b64_tr_b16 v[84:85], v11 offset:8192
    v_mfma_f32_16x16x32_bf16 v[116:119], v[212:215], v[72:75], v[116:119]
    ds_read_b64_tr_b16 v[86:87], v11 offset:9216
    s_waitcnt lgkmcnt(6)
    v_mfma_f32_16x16x32_bf16 v[120:123], v[208:211], v[76:79], v[120:123]
    ds_read_b64_tr_b16 v[88:89], v12 offset:8192
    ds_read_b64_tr_b16 v[90:91], v12 offset:9216
    s_add_u32 m0, s76, 82944
    s_nop 0
    buffer_load_dwordx4 v4, s[8:11], s75 offen lds
    v_mfma_f32_16x16x32_bf16 v[124:127], v[212:215], v[76:79], v[124:127]
    ds_read_b64_tr_b16 v[92:93], v13 offset:8192
    ds_read_b64_tr_b16 v[94:95], v13 offset:9216
    s_waitcnt lgkmcnt(6)
    v_mfma_f32_16x16x32_bf16 v[96:99], v[80:83], v[216:219], v[96:99]
    s_waitcnt vmcnt(4)
    s_barrier
    v_add_u32 v8, 0x8000, v8
    v_add_u32 v9, 0x8000, v9
    v_add_u32 v10, 0x8000, v10
    v_add_u32 v11, 0x8000, v11
    v_add_u32 v12, 0x8000, v12
    v_add_u32 v13, 0x8000, v13
    ds_read_b128 v[224:227], v8 offset:0
    v_mfma_f32_16x16x32_bf16 v[100:103], v[80:83], v[220:223], v[100:103]
    ds_read_b128 v[228:231], v8 offset:2048
    s_waitcnt lgkmcnt(6)
    v_mfma_f32_16x16x32_bf16 v[104:107], v[84:87], v[216:219], v[104:107]
    ds_read_b64_tr_b16 v[64:65], v10 offset:0
    v_mfma_f32_16x16x32_bf16 v[108:111], v[84:87], v[220:223], v[108:111]
    ds_read_b64_tr_b16 v[66:67], v10 offset:1024
    s_waitcnt lgkmcnt(6)
    v_mfma_f32_16x16x32_bf16 v[112:115], v[216:219], v[88:91], v[112:115]
    ds_read_b64_tr_b16 v[68:69], v11 offset:0
    s_add_u32 m0, s77, 98304
    s_nop 0
    buffer_load_dwordx4 v5, s[12:15], s68 offen lds
    v_mfma_f32_16x16x32_bf16 v[116:119], v[220:223], v[88:91], v[116:119]
    ds_read_b64_tr_b16 v[70:71], v11 offset:1024
    s_waitcnt lgkmcnt(6)
    v_mfma_f32_16x16x32_bf16 v[120:123], v[216:219], v[92:95], v[120:123]
    ds_read_b64_tr_b16 v[72:73], v12 offset:0
    ds_read_b64_tr_b16 v[74:75], v12 offset:1024
    v_mfma_f32_16x16x32_bf16 v[124:127], v[220:223], v[92:95], v[124:127]
    ds_read_b64_tr_b16 v[76:77], v13 offset:0
    ds_read_b64_tr_b16 v[78:79], v13 offset:1024
    s_waitcnt lgkmcnt(6)
    v_mfma_f32_16x16x32_bf16 v[96:99], v[64:67], v[224:227], v[96:99]
    ds_read_b128 v[232:235], v9 offset:0
    v_mfma_f32_16x16x32_bf16 v[100:103], v[64:67], v[228:231], v[100:103]
    ds_read_b128 v[236:239], v9 offset:2048
    s_waitcnt lgkmcnt(6)
    v_mfma_f32_16x16x32_bf16 v[104:107], v[68:71], v[224:227], v[104:107]
    ds_read_b64_tr_b16 v[80:81], v10 offset:8192
    v_mfma_f32_16x16x32_bf16 v[108:111], v[68:71], v[228:231], v[108:111]
    ds_read_b64_tr_b16 v[82:83], v10 offset:9216
    s_waitcnt lgkmcnt(6)
    v_mfma_f32_16x16x32_bf16 v[112:115], v[224:227], v[72:75], v[112:115]
    ds_read_b64_tr_b16 v[84:85], v11 offset:8192
    s_add_u32 m0, s77, 106496
    s_nop 0
    buffer_load_dwordx4 v5, s[12:15], s69 offen lds
    v_mfma_f32_16x16x32_bf16 v[116:119], v[228:231], v[72:75], v[116:119]
    ds_read_b64_tr_b16 v[86:87], v11 offset:9216
    s_waitcnt lgkmcnt(6)
    v_mfma_f32_16x16x32_bf16 v[120:123], v[224:227], v[76:79], v[120:123]
    ds_read_b64_tr_b16 v[88:89], v12 offset:8192
    ds_read_b64_tr_b16 v[90:91], v12 offset:9216
    v_mfma_f32_16x16x32_bf16 v[124:127], v[228:231], v[76:79], v[124:127]
    ds_read_b64_tr_b16 v[92:93], v13 offset:8192
    ds_read_b64_tr_b16 v[94:95], v13 offset:9216
    s_waitcnt lgkmcnt(6)
    v_mfma_f32_16x16x32_bf16 v[96:99], v[80:83], v[232:235], v[96:99]
    s_waitcnt vmcnt(2)
    s_barrier
    v_add_u32 v8, 0x8000, v8
    v_add_u32 v9, 0x8000, v9
    v_add_u32 v10, 0x8000, v10
    v_add_u32 v11, 0x8000, v11
    v_add_u32 v12, 0x8000, v12
    v_add_u32 v13, 0x8000, v13
    ds_read_b128 v[240:243], v8 offset:0
    v_mfma_f32_16x16x32_bf16 v[100:103], v[80:83], v[236:239], v[100:103]
    ds_read_b128 v[244:247], v8 offset:2048
    s_waitcnt lgkmcnt(6)
    v_mfma_f32_16x16x32_bf16 v[104:107], v[84:87], v[232:235], v[104:107]
    ds_read_b64_tr_b16 v[64:65], v10 offset:0
    v_mfma_f32_16x16x32_bf16 v[108:111], v[84:87], v[236:239], v[108:111]
    ds_read_b64_tr_b16 v[66:67], v10 offset:1024
    s_waitcnt lgkmcnt(6)
    v_mfma_f32_16x16x32_bf16 v[112:115], v[232:235], v[88:91], v[112:115]
    ds_read_b64_tr_b16 v[68:69], v11 offset:0
    s_add_u32 m0, s77, 114688
    s_nop 0
    buffer_load_dwordx4 v5, s[12:15], s70 offen lds
    v_mfma_f32_16x16x32_bf16 v[116:119], v[236:239], v[88:91], v[116:119]
    ds_read_b64_tr_b16 v[70:71], v11 offset:1024
    s_waitcnt lgkmcnt(6)
    v_mfma_f32_16x16x32_bf16 v[120:123], v[232:235], v[92:95], v[120:123]
    ds_read_b64_tr_b16 v[72:73], v12 offset:0
    ds_read_b64_tr_b16 v[74:75], v12 offset:1024
    v_mfma_f32_16x16x32_bf16 v[124:127], v[236:239], v[92:95], v[124:127]
    ds_read_b64_tr_b16 v[76:77], v13 offset:0
    ds_read_b64_tr_b16 v[78:79], v13 offset:1024
    s_waitcnt lgkmcnt(6)
    v_mfma_f32_16x16x32_bf16 v[96:99], v[64:67], v[240:243], v[96:99]
    ds_read_b128 v[248:251], v9 offset:0
    v_mfma_f32_16x16x32_bf16 v[100:103], v[64:67], v[244:247], v[100:103]
    ds_read_b128 v[252:255], v9 offset:2048
    s_waitcnt lgkmcnt(6)
    v_mfma_f32_16x16x32_bf16 v[104:107], v[68:71], v[240:243], v[104:107]
    ds_read_b64_tr_b16 v[80:81], v10 offset:8192
    v_mfma_f32_16x16x32_bf16 v[108:111], v[68:71], v[244:247], v[108:111]
    ds_read_b64_tr_b16 v[82:83], v10 offset:9216
    s_waitcnt lgkmcnt(6)
    v_mfma_f32_16x16x32_bf16 v[112:115], v[240:243], v[72:75], v[112:115]
    ds_read_b64_tr_b16 v[84:85], v11 offset:8192
    s_add_u32 m0, s77, 122880
    s_nop 0
    buffer_load_dwordx4 v5, s[12:15], s71 offen lds
    v_mfma_f32_16x16x32_bf16 v[116:119], v[244:247], v[72:75], v[116:119]
    ds_read_b64_tr_b16 v[86:87], v11 offset:9216
    s_waitcnt lgkmcnt(6)
    v_mfma_f32_16x16x32_bf16 v[120:123], v[240:243], v[76:79], v[120:123]
    ds_read_b64_tr_b16 v[88:89], v12 offset:8192
    ds_read_b64_tr_b16 v[90:91], v12 offset:9216
    v_mfma_f32_16x16x32_bf16 v[124:127], v[244:247], v[76:79], v[124:127]
    ds_read_b64_tr_b16 v[92:93], v13 offset:8192
    ds_read_b64_tr_b16 v[94:95], v13 offset:9216
    s_waitcnt lgkmcnt(6)
    v_mfma_f32_16x16x32_bf16 v[96:99], v[80:83], v[248:251], v[96:99]
    v_mfma_f32_16x16x32_bf16 v[100:103], v[80:83], v[252:255], v[100:103]
    s_waitcnt lgkmcnt(4)
    v_mfma_f32_16x16x32_bf16 v[104:107], v[84:87], v[248:251], v[104:107]
    v_mfma_f32_16x16x32_bf16 v[108:111], v[84:87], v[252:255], v[108:111]
    s_waitcnt lgkmcnt(2)
    v_mfma_f32_16x16x32_bf16 v[112:115], v[248:251], v[88:91], v[112:115]
    v_mfma_f32_16x16x32_bf16 v[116:119], v[252:255], v[88:91], v[116:119]
    s_waitcnt lgkmcnt(0)
    v_mfma_f32_16x16x32_bf16 v[120:123], v[248:251], v[92:95], v[120:123]
    v_mfma_f32_16x16x32_bf16 v[124:127], v[252:255], v[92:95], v[124:127]
    s_barrier
    v_mov_b32 v56, -1
    v_mov_b32 v57, -1
    v_mov_b32 v58, -1
    v_mov_b32 v59, -1
    s_lshl_b32 s54, s40, 3
    s_lshl_b32 s55, s46, 1
    s_add_u32 s54, s54, s55
    s_lshl_b32 s54, s54, 5
    s_lshl_b32 s55, s41, 1
    s_add_u32 s54, s54, s55
    s_add_u32 s54, s54, s45
    s_add_u32 s54, s54, 0
    s_lshl_b32 s54, s54, 10
    s_add_u32 s54, s54, 0x100000
    v_add_u32 v12, s54, v18
    s_mov_b32 s55, 0x8000
    buffer_store_dwordx4 v[56:59], v12, s[24:27], 0 offen sc1
    buffer_store_dwordx4 v[56:59], v12, s[24:27], s55 offen sc1
    s_lshr_b32 s54, s41, 1
    s_cmp_eq_u32 s44, s54
    s_cbranch_scc1 Lout_34
Lback_35:
    s_cmp_eq_u32 s44, 5
    s_cbranch_scc1 Lout_36
Lback_37:
    v_mov_b32 v8, 0x3fb8aa3b
    v_mov_b32 v9, 0x358637bd
    v_cvt_pk_bf16_f32 v32, v112, v113
    v_cvt_pk_bf16_f32 v33, v114, v115
    v_cvt_pk_bf16_f32 v34, v116, v117
    v_cvt_pk_bf16_f32 v35, v118, v119
    v_cvt_pk_bf16_f32 v36, v120, v121
    v_cvt_pk_bf16_f32 v37, v122, v123
    v_cvt_pk_bf16_f32 v38, v124, v125
    v_cvt_pk_bf16_f32 v39, v126, v127
    v_cvt_pk_bf16_f32 v64, v96, v97
    v_cvt_pk_bf16_f32 v65, v98, v99
    v_cvt_pk_bf16_f32 v66, v100, v101
    v_cvt_pk_bf16_f32 v67, v102, v103
    v_cvt_pk_bf16_f32 v68, v104, v105
    v_cvt_pk_bf16_f32 v69, v106, v107
    v_cvt_pk_bf16_f32 v70, v108, v109
    v_cvt_pk_bf16_f32 v71, v110, v111
    v_mfma_f32_16x16x16_bf16 v[96:99], v[22:23], v[64:65], 0
    v_mfma_f32_16x16x16_bf16 v[100:103], v[22:23], v[66:67], 0
    v_mfma_f32_16x16x16_bf16 v[104:107], v[24:25], v[68:69], 0
    s_add_u32 m0, s77, 131072
    s_nop 0
    buffer_load_dwordx4 v5, s[12:15], s72 offen lds
    v_mfma_f32_16x16x16_bf16 v[108:111], v[24:25], v[70:71], 0
    s_nop 1
    v_max3_f32 v72, v96, v97, v98
    v_max3_f32 v73, v100, v101, v102
    v_max3_f32 v74, v104, v105, v106
    s_nop 2
    v_max3_f32 v75, v108, v109, v110
    v_max3_f32 v76, -v96, -v97, -v98
    v_max3_f32 v77, -v100, -v101, -v102
    v_max3_f32 v78, -v104, -v105, -v106
    v_max3_f32 v79, -v108, -v109, -v110
    v_max_f32 v72, v72, v99
    v_max_f32 v73, v73, v103
    v_max_f32 v74, v74, v107
    v_max_f32 v75, v75, v111
    v_max_f32_e64 v76, v76, -v99
    v_max_f32_e64 v77, v77, -v103
    v_max_f32_e64 v78, v78, -v107
    v_max_f32_e64 v79, v79, -v111
    v_permlane16_swap_b32 v72, v76
    v_permlane16_swap_b32 v73, v77
    v_permlane16_swap_b32 v74, v78
    v_permlane16_swap_b32 v75, v79
    v_max_f32 v72, v72, v76
    v_max_f32 v73, v73, v77
    v_max_f32 v74, v74, v78
    v_max_f32 v75, v75, v79
    v_mov_b32 v76, v72
    s_add_u32 m0, s77, 139264
    s_nop 0
    buffer_load_dwordx4 v5, s[12:15], s73 offen lds
    v_mov_b32 v77, v73
    v_mov_b32 v78, v74
    v_mov_b32 v79, v75
    v_permlane32_swap_b32 v72, v76
    v_permlane32_swap_b32 v73, v77
    v_permlane32_swap_b32 v74, v78
    v_permlane32_swap_b32 v75, v79
    v_max_f32 v72, v72, v76
    v_max_f32 v73, v73, v77
    v_max_f32 v74, v74, v78
    v_max_f32 v75, v75, v79
    v_mov_b32 v76, v72
    v_mov_b32 v77, v73
    v_mov_b32 v78, v74
    v_mov_b32 v79, v75
    v_permlane16_swap_b32 v72, v76
    v_permlane16_swap_b32 v73, v77
    v_permlane16_swap_b32 v74, v78
    v_permlane16_swap_b32 v75, v79
    v_mul_f32 v72, v19, v72
    v_mul_f32 v73, v19, v73
    v_mul_f32 v74, v19, v74
    v_mul_f32 v75, v19, v75
    v_mul_f32 v76, v19, v76
    v_mul_f32 v77, v19, v77
    v_mul_f32 v78, v19, v78
    s_add_u32 m0, s77, 147456
    s_nop 0
    buffer_load_dwordx4 v5, s[12:15], s74 offen lds
    v_mul_f32 v79, v19, v79
    v_pk_fma_f32 v[112:113], v[96:97], v[8:9], v[76:77] op_sel:[0,0,0] op_sel_hi:[1,0,0] neg_lo:[1,0,1] neg_hi:[1,0,1]
    v_pk_fma_f32 v[114:115], v[98:99], v[8:9], v[76:77] op_sel:[0,0,0] op_sel_hi:[1,0,0] neg_lo:[1,0,1] neg_hi:[1,0,1]
    v_pk_fma_f32 v[116:117], v[100:101], v[8:9], v[76:77] op_sel:[0,0,1] op_sel_hi:[1,0,1] neg_lo:[1,0,1] neg_hi:[1,0,1]
    v_pk_fma_f32 v[118:119], v[102:103], v[8:9], v[76:77] op_sel:[0,0,1] op_sel_hi:[1,0,1] neg_lo:[1,0,1] neg_hi:[1,0,1]
    v_pk_fma_f32 v[120:121], v[104:105], v[8:9], v[78:79] op_sel:[0,0,0] op_sel_hi:[1,0,0] neg_lo:[1,0,1] neg_hi:[1,0,1]
    v_pk_fma_f32 v[122:123], v[106:107], v[8:9], v[78:79] op_sel:[0,0,0] op_sel_hi:[1,0,0] neg_lo:[1,0,1] neg_hi:[1,0,1]
    v_pk_fma_f32 v[124:125], v[108:109], v[8:9], v[78:79] op_sel:[0,0,1] op_sel_hi:[1,0,1] neg_lo:[1,0,1] neg_hi:[1,0,1]
    v_pk_fma_f32 v[126:127], v[110:111], v[8:9], v[78:79] op_sel:[0,0,1] op_sel_hi:[1,0,1] neg_lo:[1,0,1] neg_hi:[1,0,1]
    v_pk_fma_f32 v[96:97], v[96:97], v[8:9], v[72:73] op_sel:[0,0,0] op_sel_hi:[1,0,0] neg_lo:[0,0,1] neg_hi:[0,0,1]
    v_pk_fma_f32 v[98:99], v[98:99], v[8:9], v[72:73] op_sel:[0,0,0] op_sel_hi:[1,0,0] neg_lo:[0,0,1] neg_hi:[0,0,1]
    v_pk_fma_f32 v[100:101], v[100:101], v[8:9], v[72:73] op_sel:[0,0,1] op_sel_hi:[1,0,1] neg_lo:[0,0,1] neg_hi:[0,0,1]
    v_pk_fma_f32 v[102:103], v[102:103], v[8:9], v[72:73] op_sel:[0,0,1] op_sel_hi:[1,0,1] neg_lo:[0,0,1] neg_hi:[0,0,1]
    v_pk_fma_f32 v[104:105], v[104:105], v[8:9], v[74:75] op_sel:[0,0,0] op_sel_hi:[1,0,0] neg_lo:[0,0,1] neg_hi:[0,0,1]
    v_pk_fma_f32 v[106:107], v[106:107], v[8:9], v[74:75] op_sel:[0,0,0] op_sel_hi:[1,0,0] neg_lo:[0,0,1] neg_hi:[0,0,1]
    v_pk_fma_f32 v[108:109], v[108:109], v[8:9], v[74:75] op_sel:[0,0,1] op_sel_hi:[1,0,1] neg_lo:[0,0,1] neg_hi:[0,0,1]
    v_pk_fma_f32 v[110:111], v[110:111], v[8:9], v[74:75] op_sel:[0,0,1] op_sel_hi:[1,0,1] neg_lo:[0,0,1] neg_hi:[0,0,1]
    v_exp_f32 v112, v112
    v_exp_f32 v113, v113
    v_exp_f32 v114, v114
    v_exp_f32 v115, v115
    v_exp_f32 v116, v116
    v_exp_f32 v117, v117
    v_exp_f32 v118, v118
    v_exp_f32 v119, v119
    v_exp_f32 v120, v120
    s_add_u32 m0, s77, 155648
    s_nop 0
    buffer_load_dwordx4 v5, s[12:15], s75 offen lds
    v_exp_f32 v121, v121
    v_exp_f32 v122, v122
    v_exp_f32 v123, v123
    v_exp_f32 v124, v124
    v_exp_f32 v125, v125
    v_exp_f32 v126, v126
    v_exp_f32 v127, v127
    v_exp_f32 v96, v96
    v_exp_f32 v97, v97
    v_exp_f32 v98, v98
    v_exp_f32 v99, v99
    v_exp_f32 v100, v100
    v_exp_f32 v101, v101
    v_exp_f32 v102, v102
    v_exp_f32 v103, v103
    v_exp_f32 v104, v104
    v_exp_f32 v105, v105
    v_exp_f32 v106, v106
    v_exp_f32 v107, v107
    v_exp_f32 v108, v108
    v_exp_f32 v109, v109
    v_exp_f32 v110, v110
    v_exp_f32 v111, v111
    v_pk_add_f32 v[64:65], v[112:113], v[114:115]
    v_pk_add_f32 v[66:67], v[116:117], v[118:119]
    v_pk_add_f32 v[68:69], v[120:121], v[122:123]
    s_add_u32 m0, s76, 0
    s_nop 0
    buffer_load_dwordx4 v6, s[16:19], s80 offen lds
    v_pk_add_f32 v[70:71], v[124:125], v[126:127]
    v_add_f32 v76, v64, v65
    v_add_f32 v77, v66, v67
    v_add_f32 v78, v68, v69
    v_add_f32 v79, v70, v71
    v_pk_add_f32 v[64:65], v[96:97], v[98:99]
    v_pk_add_f32 v[66:67], v[100:101], v[102:103]
    v_pk_add_f32 v[68:69], v[104:105], v[106:107]
    v_pk_add_f32 v[70:71], v[108:109], v[110:111]
    v_add_f32 v72, v64, v65
    v_add_f32 v73, v66, v67
    v_add_f32 v74, v68, v69
    v_add_f32 v75, v70, v71
    v_permlane16_swap_b32 v72, v76
    v_permlane16_swap_b32 v73, v77
    v_permlane16_swap_b32 v74, v78
    v_permlane16_swap_b32 v75, v79
    v_add_f32 v72, v72, v76
    v_add_f32 v73, v73, v77
    v_add_f32 v74, v74, v78
    v_add_f32 v75, v75, v79
    v_mov_b32 v76, v72
    v_mov_b32 v77, v73
    v_mov_b32 v78, v74
    v_mov_b32 v79, v75
    v_permlane32_swap_b32 v72, v76
    s_add_u32 m0, s76, 1024
    s_nop 0
    buffer_load_dwordx4 v7, s[16:19], s80 offen lds
    v_permlane32_swap_b32 v73, v77
    v_permlane32_swap_b32 v74, v78
    v_permlane32_swap_b32 v75, v79
    v_add_f32 v72, v72, v76
    v_add_f32 v73, v73, v77
    v_add_f32 v74, v74, v78
    v_add_f32 v75, v75, v79
    v_mov_b32 v76, v72
    v_mov_b32 v77, v73
    v_mov_b32 v78, v74
    v_mov_b32 v79, v75
    v_permlane16_swap_b32 v72, v76
    v_permlane16_swap_b32 v73, v77
    v_permlane16_swap_b32 v74, v78
    v_permlane16_swap_b32 v75, v79
    v_rcp_f32 v72, v72
    v_rcp_f32 v73, v73
    v_rcp_f32 v74, v74
    v_rcp_f32 v75, v75
    v_rcp_f32 v76, v76
    v_rcp_f32 v77, v77
    v_rcp_f32 v78, v78
    v_rcp_f32 v79, v79
    v_pk_mul_f32 v[96:97], v[96:97], v[72:73] op_sel:[0,0] op_sel_hi:[1,0]
    v_pk_mul_f32 v[98:99], v[98:99], v[72:73] op_sel:[0,0] op_sel_hi:[1,0]
    v_pk_mul_f32 v[100:101], v[100:101], v[72:73] op_sel:[0,1] op_sel_hi:[1,1]
    s_add_u32 m0, s76, 16384
    s_nop 0
    buffer_load_dwordx4 v6, s[20:23], s80 offen lds
    v_pk_mul_f32 v[102:103], v[102:103], v[72:73] op_sel:[0,1] op_sel_hi:[1,1]
    v_pk_mul_f32 v[104:105], v[104:105], v[74:75] op_sel:[0,0] op_sel_hi:[1,0]
    v_pk_mul_f32 v[106:107], v[106:107], v[74:75] op_sel:[0,0] op_sel_hi:[1,0]
    v_pk_mul_f32 v[108:109], v[108:109], v[74:75] op_sel:[0,1] op_sel_hi:[1,1]
    v_pk_mul_f32 v[110:111], v[110:111], v[74:75] op_sel:[0,1] op_sel_hi:[1,1]
    v_pk_mul_f32 v[112:113], v[112:113], v[76:77] op_sel:[0,0] op_sel_hi:[1,0]
    v_pk_mul_f32 v[114:115], v[114:115], v[76:77] op_sel:[0,0] op_sel_hi:[1,0]
    v_pk_mul_f32 v[116:117], v[116:117], v[76:77] op_sel:[0,1] op_sel_hi:[1,1]
    v_pk_mul_f32 v[118:119], v[118:119], v[76:77] op_sel:[0,1] op_sel_hi:[1,1]
    v_pk_mul_f32 v[120:121], v[120:121], v[78:79] op_sel:[0,0] op_sel_hi:[1,0]
    v_pk_mul_f32 v[122:123], v[122:123], v[78:79] op_sel:[0,0] op_sel_hi:[1,0]
    v_pk_mul_f32 v[124:125], v[124:125], v[78:79] op_sel:[0,1] op_sel_hi:[1,1]
    v_pk_mul_f32 v[126:127], v[126:127], v[78:79] op_sel:[0,1] op_sel_hi:[1,1]
    v_cvt_pk_bf16_f32 v40, v96, v97
    v_cvt_pk_bf16_f32 v41, v98, v99
    v_cvt_pk_bf16_f32 v42, v112, v113
    v_cvt_pk_bf16_f32 v43, v114, v115
    v_cvt_pk_bf16_f32 v44, v100, v101
    v_cvt_pk_bf16_f32 v45, v102, v103
    v_cvt_pk_bf16_f32 v46, v116, v117
    v_cvt_pk_bf16_f32 v47, v118, v119
    v_cvt_pk_bf16_f32 v48, v104, v105
    v_cvt_pk_bf16_f32 v49, v106, v107
    v_cvt_pk_bf16_f32 v50, v120, v121
    v_cvt_pk_bf16_f32 v51, v122, v123
    v_cvt_pk_bf16_f32 v52, v108, v109
    s_add_u32 m0, s76, 17408
    s_nop 0
    buffer_load_dwordx4 v7, s[20:23], s80 offen lds
    v_cvt_pk_bf16_f32 v53, v110, v111
    v_cvt_pk_bf16_f32 v54, v124, v125
    v_cvt_pk_bf16_f32 v55, v126, v127
    v_mfma_f32_16x16x16_bf16 v[96:99], v[40:41], v[20:21], 0
    v_mfma_f32_16x16x16_bf16 v[100:103], v[42:43], v[20:21], 0
    v_mfma_f32_16x16x16_bf16 v[104:107], v[44:45], v[20:21], 0
    v_mfma_f32_16x16x16_bf16 v[108:111], v[46:47], v[20:21], 0
    v_mfma_f32_16x16x16_bf16 v[112:115], v[48:49], v[20:21], 0
    v_mfma_f32_16x16x16_bf16 v[116:119], v[50:51], v[20:21], 0
    v_mfma_f32_16x16x16_bf16 v[120:123], v[52:53], v[20:21], 0
    v_mfma_f32_16x16x16_bf16 v[124:127], v[54:55], v[20:21], 0
    v_mov_b32 v26, 0x3f803f80
    v_mov_b32 v27, 0x3f803f80
    v_mov_b32 v28, 0x3f803f80
    v_mov_b32 v29, 0x3f803f80
    v_cvt_pk_bf16_f32 v64, v96, v97
    v_cvt_pk_bf16_f32 v65, v98, v99
    v_cvt_pk_bf16_f32 v68, v100, v101
    v_cvt_pk_bf16_f32 v69, v102, v103
    v_cvt_pk_bf16_f32 v66, v104, v105
    v_cvt_pk_bf16_f32 v67, v106, v107
    v_cvt_pk_bf16_f32 v70, v108, v109
    v_cvt_pk_bf16_f32 v71, v110, v111
    v_cvt_pk_bf16_f32 v72, v112, v113
    v_cvt_pk_bf16_f32 v73, v114, v115
    v_cvt_pk_bf16_f32 v76, v116, v117
    v_cvt_pk_bf16_f32 v77, v118, v119
    v_cvt_pk_bf16_f32 v74, v120, v121
    v_cvt_pk_bf16_f32 v75, v122, v123
    v_cvt_pk_bf16_f32 v78, v124, v125
    v_cvt_pk_bf16_f32 v79, v126, v127
    v_mfma_f32_16x16x32_bf16 v[96:99], v[64:67], v[32:35], 0
    v_mfma_f32_16x16x32_bf16 v[100:103], v[68:71], v[32:35], 0
    v_mfma_f32_16x16x32_bf16 v[104:107], v[72:75], v[36:39], 0
    v_mfma_f32_16x16x32_bf16 v[108:111], v[76:79], v[36:39], 0
    v_mfma_f32_16x16x32_bf16 v[112:115], v[64:67], v[26:29], 0
    v_mfma_f32_16x16x32_bf16 v[116:119], v[68:71], v[26:29], 0
    v_mfma_f32_16x16x32_bf16 v[120:123], v[72:75], v[26:29], 0
    v_mfma_f32_16x16x32_bf16 v[124:127], v[76:79], v[26:29], 0
    s_mov_b32 exec_lo, 0xf000f0
    s_mov_b32 exec_hi, 0xf000f0
    s_nop 3
    v_mov_b32 v112, v116
    v_mov_b32 v113, v117
    v_mov_b32 v114, v118
    v_mov_b32 v115, v119
    s_mov_b32 exec_lo, 0xf000f00
    s_mov_b32 exec_hi, 0xf000f00
    v_mov_b32 v112, v120
    v_mov_b32 v113, v121
    v_mov_b32 v114, v122
    v_mov_b32 v115, v123
    s_mov_b32 exec_lo, 0xf000f000
    s_mov_b32 exec_hi, 0xf000f000
    v_mov_b32 v112, v124
    v_mov_b32 v113, v125
    v_mov_b32 v114, v126
    v_mov_b32 v115, v127
    s_mov_b64 exec, -1
    s_lshl_b32 s54, s44, 12
    s_add_u32 s54, s54, 0x8000
    v_add_u32 v30, s54, v18
    s_lshl_b32 s54, s44, 10
    s_add_u32 s54, s54, 0x10000
    v_add_u32 v31, s54, v18
    ds_write_b128 v30, v[96:99] offset:0
    ds_write_b128 v30, v[100:103] offset:1024
    ds_write_b128 v30, v[104:107] offset:2048
    ds_write_b128 v30, v[108:111] offset:3072
    ds_write_b128 v31, v[112:115]
    s_waitcnt vmcnt(10)
    s_waitcnt lgkmcnt(0)
    s_barrier
    s_cmp_ge_u32 s44, 4
    s_cbranch_scc1 Lz_38
    s_lshr_b32 s54, s44, 1
    s_lshl_b32 s54, s54, 14
    s_and_b32 s55, s44, 1
    s_lshl_b32 s55, s55, 11
    s_add_u32 s54, s54, s55
    s_add_u32 s54, s54, 0x8000
    v_add_u32 v30, s54, v18
    ds_read_b128 v[32:35], v30 offset:0
    ds_read_b128 v[36:39], v30 offset:4096
    ds_read_b128 v[40:43], v30 offset:8192
    ds_read_b128 v[44:47], v30 offset:12288
    ds_read_b128 v[48:51], v30 offset:1024
    ds_read_b128 v[52:55], v30 offset:5120
    ds_read_b128 v[56:59], v30 offset:9216
    ds_read_b128 v[60:63], v30 offset:13312
    s_lshl_b32 s54, s41, 4
    s_add_u32 s54, s54, s40
    s_lshl_b32 s54, s54, 2
    s_add_u32 s54, s54, s44
    s_lshl_b32 s54, s54, 10
    s_add_u32 s54, s54, 0x10000
    v_add_u32 v31, s54, v18
    s_waitcnt lgkmcnt(0)
    v_add_f32 v32, v32, v36
    v_add_f32 v33, v33, v37
    v_add_f32 v34, v34, v38
    v_add_f32 v35, v35, v39
    v_add_f32 v40, v40, v44
    v_add_f32 v41, v41, v45
    v_add_f32 v42, v42, v46
    v_add_f32 v43, v43, v47
    v_add_f32 v48, v48, v52
    v_add_f32 v49, v49, v53
    v_add_f32 v50, v50, v54
    v_add_f32 v51, v51, v55
    v_add_f32 v56, v56, v60
    v_add_f32 v57, v57, v61
    v_add_f32 v58, v58, v62
    v_add_f32 v59, v59, v63
    v_add_f32 v32, v32, v40
    v_add_f32 v33, v33, v41
    v_add_f32 v34, v34, v42
    v_add_f32 v35, v35, v43
    v_add_f32 v48, v48, v56
    v_add_f32 v49, v49, v57
    v_add_f32 v50, v50, v58
    v_add_f32 v51, v51, v59
    v_cvt_pk_bf16_f32 v26, v32, v33
    v_cvt_pk_bf16_f32 v27, v34, v35
    v_cvt_pk_bf16_f32 v28, v48, v49
    v_cvt_pk_bf16_f32 v29, v50, v51
    buffer_store_dwordx4 v[26:29], v31, s[24:27], 0 offen sc1
    s_branch Lred_39
Lz_38:
    s_cmp_lg_u32 s44, 4
    s_cbranch_scc1 Lred_39
    v_lshrrev_b32 v30, 4, v0
    v_lshlrev_b32 v30, 12, v30
    v_and_b32 v31, 3, v0
    v_lshl_add_u32 v30, v31, 8, v30
    v_bfe_u32 v31, v0, 2, 2
    v_lshl_add_u32 v30, v31, 6, v30
    v_add_u32 v30, 0x10000, v30
    s_lshl_b32 s54, s41, 4
    s_add_u32 s54, s54, s40
    s_lshl_b32 s54, s54, 9
    s_add_u32 s54, s54, 0x90000
    v_add_u32 v31, s54, v18
    s_mov_b32 exec_lo, -1
    s_mov_b32 exec_hi, 0
    ds_read_b128 v[32:35], v30 offset:0
    ds_read_b128 v[36:39], v30 offset:1024
    ds_read_b128 v[40:43], v30 offset:2048
    ds_read_b128 v[44:47], v30 offset:3072
    s_waitcnt lgkmcnt(0)
    v_add_f32 v32, v32, v36
    v_add_f32 v33, v33, v37
    v_add_f32 v34, v34, v38
    v_add_f32 v35, v35, v39
    v_add_f32 v40, v40, v44
    v_add_f32 v41, v41, v45
    v_add_f32 v42, v42, v46
    v_add_f32 v43, v43, v47
    v_add_f32 v32, v32, v40
    v_add_f32 v33, v33, v41
    v_add_f32 v34, v34, v42
    v_add_f32 v35, v35, v43
    buffer_store_dwordx4 v[32:35], v31, s[24:27], 0 offen sc1
    s_mov_b64 exec, -1
Lred_39:
    s_lshr_b32 s54, s41, 1
    s_cmp_eq_u32 s44, s54
    s_cbranch_scc1 Lout_40
Lback_41:
    ds_read_b64_tr_b16 v[64:65], v14 offset:0
    ds_read_b64_tr_b16 v[66:67], v14 offset:512
    ds_read_b64_tr_b16 v[68:69], v15 offset:0
    ds_read_b64_tr_b16 v[70:71], v15 offset:512
    ds_read_b64_tr_b16 v[72:73], v14 offset:4096
    ds_read_b64_tr_b16 v[74:75], v14 offset:4608
    ds_read_b64_tr_b16 v[76:77], v15 offset:4096
    ds_read_b64_tr_b16 v[78:79], v15 offset:4608
    s_waitcnt lgkmcnt(6)
    v_mfma_f32_16x16x32_bf16 v[96:99], v[64:67], v[128:131], 0
    ds_read_b64_tr_b16 v[80:81], v14 offset:8192
    v_mfma_f32_16x16x32_bf16 v[100:103], v[64:67], v[132:135], 0
    ds_read_b64_tr_b16 v[82:83], v14 offset:8704
    s_waitcnt lgkmcnt(6)
    v_mfma_f32_16x16x32_bf16 v[104:107], v[68:71], v[128:131], 0
    ds_read_b64_tr_b16 v[84:85], v15 offset:8192
    v_mfma_f32_16x16x32_bf16 v[108:111], v[68:71], v[132:135], 0
    ds_read_b64_tr_b16 v[86:87], v15 offset:8704
    s_waitcnt lgkmcnt(6)
    v_mfma_f32_16x16x32_bf16 v[96:99], v[72:75], v[136:139], v[96:99]
    ds_read_b64_tr_b16 v[88:89], v14 offset:12288
    v_mfma_f32_16x16x32_bf16 v[100:103], v[72:75], v[140:143], v[100:103]
    ds_read_b64_tr_b16 v[90:91], v14 offset:12800
    s_waitcnt lgkmcnt(6)
    v_mfma_f32_16x16x32_bf16 v[104:107], v[76:79], v[136:139], v[104:107]
    ds_read_b64_tr_b16 v[92:93], v15 offset:12288
    v_mfma_f32_16x16x32_bf16 v[108:111], v[76:79], v[140:143], v[108:111]
    ds_read_b64_tr_b16 v[94:95], v15 offset:12800
    s_waitcnt lgkmcnt(6)
    v_mfma_f32_16x16x32_bf16 v[96:99], v[80:83], v[144:147], v[96:99]
    ds_read_b64_tr_b16 v[64:65], v14 offset:16384
    v_mfma_f32_16x16x32_bf16 v[100:103], v[80:83], v[148:151], v[100:103]
    ds_read_b64_tr_b16 v[66:67], v14 offset:16896
    s_waitcnt lgkmcnt(6)
    v_mfma_f32_16x16x32_bf16 v[104:107], v[84:87], v[144:147], v[104:107]
    ds_read_b64_tr_b16 v[68:69], v15 offset:16384
    v_mfma_f32_16x16x32_bf16 v[108:111], v[84:87], v[148:151], v[108:111]
    ds_read_b64_tr_b16 v[70:71], v15 offset:16896
    s_waitcnt lgkmcnt(6)
    v_mfma_f32_16x16x32_bf16 v[96:99], v[88:91], v[152:155], v[96:99]
    ds_read_b64_tr_b16 v[72:73], v14 offset:20480
    v_mfma_f32_16x16x32_bf16 v[100:103], v[88:91], v[156:159], v[100:103]
    ds_read_b64_tr_b16 v[74:75], v14 offset:20992
    s_waitcnt lgkmcnt(6)
    v_mfma_f32_16x16x32_bf16 v[104:107], v[92:95], v[152:155], v[104:107]
    ds_read_b64_tr_b16 v[76:77], v15 offset:20480
    v_mfma_f32_16x16x32_bf16 v[108:111], v[92:95], v[156:159], v[108:111]
    ds_read_b64_tr_b16 v[78:79], v15 offset:20992
    s_waitcnt lgkmcnt(6)
    v_mfma_f32_16x16x32_bf16 v[96:99], v[64:67], v[160:163], v[96:99]
    s_cmp_eq_u32 s44, 5
    s_cbranch_scc1 Lout_42
Lback_43:
    s_waitcnt vmcnt(4)
    s_barrier
    s_cmp_ge_u32 s44, 7
    s_cbranch_scc1 Lout_46
Lback_47:
    s_lshl_b32 s54, s41, 4
    s_and_b32 s55, s44, 3
    s_lshl_b32 s55, s55, 2
    s_add_u32 s54, s54, s55
    s_lshl_b32 s54, s54, 1
    s_lshr_b32 s55, s44, 2
    s_add_u32 s54, s54, s55
    s_lshl_b32 s54, s54, 10
    s_add_u32 s54, s54, 0xa0000
    v_add_u32 v31, s54, v18
    ds_read_b64_tr_b16 v[80:81], v14 offset:24576
    v_mfma_f32_16x16x32_bf16 v[100:103], v[64:67], v[164:167], v[100:103]
    ds_read_b64_tr_b16 v[82:83], v14 offset:25088
    s_mov_b32 s55, 0
    buffer_load_dwordx4 v[112:115], v31, s[24:27], s55 offen sc1
    s_waitcnt lgkmcnt(6)
    v_mfma_f32_16x16x32_bf16 v[104:107], v[68:71], v[160:163], v[104:107]
    ds_read_b64_tr_b16 v[84:85], v15 offset:24576
    v_mfma_f32_16x16x32_bf16 v[108:111], v[68:71], v[164:167], v[108:111]
    ds_read_b64_tr_b16 v[86:87], v15 offset:25088
    s_waitcnt lgkmcnt(6)
    v_mfma_f32_16x16x32_bf16 v[96:99], v[72:75], v[168:171], v[96:99]
    ds_read_b64_tr_b16 v[88:89], v14 offset:28672
    s_mov_b32 s55, 2048
    buffer_load_dwordx4 v[116:119], v31, s[24:27], s55 offen sc1
    v_mfma_f32_16x16x32_bf16 v[100:103], v[72:75], v[172:175], v[100:103]
    ds_read_b64_tr_b16 v[90:91], v14 offset:29184
    s_waitcnt lgkmcnt(6)
    v_mfma_f32_16x16x32_bf16 v[104:107], v[76:79], v[168:171], v[104:107]
    ds_read_b64_tr_b16 v[92:93], v15 offset:28672
    s_mov_b32 s55, 4096
    buffer_load_dwordx4 v[120:123], v31, s[24:27], s55 offen sc1
    v_mfma_f32_16x16x32_bf16 v[108:111], v[76:79], v[172:175], v[108:111]
    ds_read_b64_tr_b16 v[94:95], v15 offset:29184
    v_add_u32 v14, 0x8000, v14
    v_add_u32 v15, 0x8000, v15
    s_waitcnt lgkmcnt(6)
    v_mfma_f32_16x16x32_bf16 v[96:99], v[80:83], v[176:179], v[96:99]
    ds_read_b64_tr_b16 v[64:65], v14 offset:0
    v_mfma_f32_16x16x32_bf16 v[100:103], v[80:83], v[180:183], v[100:103]
    ds_read_b64_tr_b16 v[66:67], v14 offset:512
    s_mov_b32 s55, 6144
    buffer_load_dwordx4 v[124:127], v31, s[24:27], s55 offen sc1
    s_waitcnt lgkmcnt(6)
    v_mfma_f32_16x16x32_bf16 v[104:107], v[84:87], v[176:179], v[104:107]
    ds_read_b64_tr_b16 v[68:69], v15 offset:0
    v_mfma_f32_16x16x32_bf16 v[108:111], v[84:87], v[180:183], v[108:111]
    ds_read_b64_tr_b16 v[70:71], v15 offset:512
    s_waitcnt lgkmcnt(6)
    v_mfma_f32_16x16x32_bf16 v[96:99], v[88:91], v[184:187], v[96:99]
    ds_read_b64_tr_b16 v[72:73], v14 offset:4096
    s_add_u32 m0, s76, 32768
    s_nop 0
    buffer_load_dwordx4 v6, s[16:19], s81 offen lds
    v_mfma_f32_16x16x32_bf16 v[100:103], v[88:91], v[188:191], v[100:103]
    ds_read_b64_tr_b16 v[74:75], v14 offset:4608
    s_waitcnt lgkmcnt(6)
    v_mfma_f32_16x16x32_bf16 v[104:107], v[92:95], v[184:187], v[104:107]
    ds_read_b64_tr_b16 v[76:77], v15 offset:4096
    s_add_u32 m0, s76, 33792
    s_nop 0
    buffer_load_dwordx4 v7, s[16:19], s81 offen lds
    v_mfma_f32_16x16x32_bf16 v[108:111], v[92:95], v[188:191], v[108:111]
    ds_read_b64_tr_b16 v[78:79], v15 offset:4608
    s_lshr_b32 s54, s41, 1
    s_cmp_eq_u32 s44, s54
    s_cbranch_scc1 Lout_48
Lback_49:
    s_waitcnt lgkmcnt(6)
    v_mfma_f32_16x16x32_bf16 v[96:99], v[64:67], v[192:195], v[96:99]
    ds_read_b64_tr_b16 v[80:81], v14 offset:8192
    v_mfma_f32_16x16x32_bf16 v[100:103], v[64:67], v[196:199], v[100:103]
    ds_read_b64_tr_b16 v[82:83], v14 offset:8704
    s_add_u32 m0, s76, 49152
    s_nop 0
    buffer_load_dwordx4 v6, s[20:23], s81 offen lds
    s_waitcnt lgkmcnt(6)
    v_mfma_f32_16x16x32_bf16 v[104:107], v[68:71], v[192:195], v[104:107]
    ds_read_b64_tr_b16 v[84:85], v15 offset:8192
    v_mfma_f32_16x16x32_bf16 v[108:111], v[68:71], v[196:199], v[108:111]
    ds_read_b64_tr_b16 v[86:87], v15 offset:8704
    s_waitcnt lgkmcnt(6)
    v_mfma_f32_16x16x32_bf16 v[96:99], v[72:75], v[200:203], v[96:99]
    ds_read_b64_tr_b16 v[88:89], v14 offset:12288
    s_add_u32 m0, s76, 50176
    s_nop 0
    buffer_load_dwordx4 v7, s[20:23], s81 offen lds
    v_mfma_f32_16x16x32_bf16 v[100:103], v[72:75], v[204:207], v[100:103]
    ds_read_b64_tr_b16 v[90:91], v14 offset:12800
    s_waitcnt lgkmcnt(6)
    v_mfma_f32_16x16x32_bf16 v[104:107], v[76:79], v[200:203], v[104:107]
    ds_read_b64_tr_b16 v[92:93], v15 offset:12288
    s_add_u32 m0, s76, 65536
    s_nop 0
    buffer_load_dwordx4 v6, s[16:19], s82 offen lds
    v_mfma_f32_16x16x32_bf16 v[108:111], v[76:79], v[204:207], v[108:111]
    ds_read_b64_tr_b16 v[94:95], v15 offset:12800
    s_waitcnt lgkmcnt(6)
    v_mfma_f32_16x16x32_bf16 v[96:99], v[80:83], v[208:211], v[96:99]
    ds_read_b64_tr_b16 v[64:65], v14 offset:16384
    v_mfma_f32_16x16x32_bf16 v[100:103], v[80:83], v[212:215], v[100:103]
    ds_read_b64_tr_b16 v[66:67], v14 offset:16896
    s_add_u32 m0, s76, 66560
    s_nop 0
    buffer_load_dwordx4 v7, s[16:19], s82 offen lds
    s_waitcnt lgkmcnt(6)
    v_mfma_f32_16x16x32_bf16 v[104:107], v[84:87], v[208:211], v[104:107]
    ds_read_b64_tr_b16 v[68:69], v15 offset:16384
    v_mfma_f32_16x16x32_bf16 v[108:111], v[84:87], v[212:215], v[108:111]
    ds_read_b64_tr_b16 v[70:71], v15 offset:16896
    s_waitcnt lgkmcnt(6)
    v_mfma_f32_16x16x32_bf16 v[96:99], v[88:91], v[216:219], v[96:99]
    ds_read_b64_tr_b16 v[72:73], v14 offset:20480
    s_add_u32 m0, s76, 81920
    s_nop 0
    buffer_load_dwordx4 v6, s[20:23], s82 offen lds
    v_mfma_f32_16x16x32_bf16 v[100:103], v[88:91], v[220:223], v[100:103]
    ds_read_b64_tr_b16 v[74:75], v14 offset:20992
    s_waitcnt lgkmcnt(6)
    v_mfma_f32_16x16x32_bf16 v[104:107], v[92:95], v[216:219], v[104:107]
    ds_read_b64_tr_b16 v[76:77], v15 offset:20480
    s_add_u32 m0, s76, 82944
    s_nop 0
    buffer_load_dwordx4 v7, s[20:23], s82 offen lds
    v_mfma_f32_16x16x32_bf16 v[108:111], v[92:95], v[220:223], v[108:111]
    ds_read_b64_tr_b16 v[78:79], v15 offset:20992
    s_waitcnt lgkmcnt(6)
    v_mfma_f32_16x16x32_bf16 v[96:99], v[64:67], v[224:227], v[96:99]
    ds_read_b64_tr_b16 v[80:81], v14 offset:24576
    v_mfma_f32_16x16x32_bf16 v[100:103], v[64:67], v[228:231], v[100:103]
    ds_read_b64_tr_b16 v[82:83], v14 offset:25088
    s_waitcnt lgkmcnt(6)
    v_mfma_f32_16x16x32_bf16 v[104:107], v[68:71], v[224:227], v[104:107]
    ds_read_b64_tr_b16 v[84:85], v15 offset:24576
    v_mfma_f32_16x16x32_bf16 v[108:111], v[68:71], v[228:231], v[108:111]
    ds_read_b64_tr_b16 v[86:87], v15 offset:25088
    s_waitcnt lgkmcnt(6)
    v_mfma_f32_16x16x32_bf16 v[96:99], v[72:75], v[232:235], v[96:99]
    ds_read_b64_tr_b16 v[88:89], v14 offset:28672
    v_mfma_f32_16x16x32_bf16 v[100:103], v[72:75], v[236:239], v[100:103]
    ds_read_b64_tr_b16 v[90:91], v14 offset:29184
    s_waitcnt lgkmcnt(6)
    v_mfma_f32_16x16x32_bf16 v[104:107], v[76:79], v[232:235], v[104:107]
    ds_read_b64_tr_b16 v[92:93], v15 offset:28672
    v_mfma_f32_16x16x32_bf16 v[108:111], v[76:79], v[236:239], v[108:111]
    ds_read_b64_tr_b16 v[94:95], v15 offset:29184
    s_waitcnt lgkmcnt(6)
    v_mfma_f32_16x16x32_bf16 v[96:99], v[80:83], v[240:243], v[96:99]
    v_mfma_f32_16x16x32_bf16 v[100:103], v[80:83], v[244:247], v[100:103]
    s_waitcnt lgkmcnt(4)
    v_mfma_f32_16x16x32_bf16 v[104:107], v[84:87], v[240:243], v[104:107]
    v_mfma_f32_16x16x32_bf16 v[108:111], v[84:87], v[244:247], v[108:111]
    s_waitcnt lgkmcnt(2)
    v_mfma_f32_16x16x32_bf16 v[96:99], v[88:91], v[248:251], v[96:99]
    v_mfma_f32_16x16x32_bf16 v[100:103], v[88:91], v[252:255], v[100:103]
    s_waitcnt lgkmcnt(0)
    v_mfma_f32_16x16x32_bf16 v[104:107], v[92:95], v[248:251], v[104:107]
    v_mfma_f32_16x16x32_bf16 v[108:111], v[92:95], v[252:255], v[108:111]
    s_lshr_b32 s54, s41, 1
    s_cmp_eq_u32 s44, s54
    s_cbranch_scc1 Lout_52
Lback_53:
    s_waitcnt vmcnt(4)
    s_barrier
    s_cmp_eq_u32 s44, 5
    s_cbranch_scc1 Lout_56
Lback_57:
    s_cmp_ge_u32 s44, 7
    s_cbranch_scc1 Lout_58
Lback_59:
    v_pk_mul_f32 v[48:49], v[96:97], v[8:9] op_sel_hi:[1,0]
    ds_read_b64_tr_b16 v[128:129], v16 offset:0
    v_pk_mul_f32 v[50:51], v[98:99], v[8:9] op_sel_hi:[1,0]
    v_pk_mul_f32 v[52:53], v[100:101], v[8:9] op_sel_hi:[1,0]
    ds_read_b64_tr_b16 v[130:131], v16 offset:2048
    v_pk_mul_f32 v[54:55], v[102:103], v[8:9] op_sel_hi:[1,0]
    v_pk_mul_f32 v[56:57], v[104:105], v[8:9] op_sel_hi:[1,0]
    ds_read_b64_tr_b16 v[132:133], v17 offset:0
    v_pk_mul_f32 v[58:59], v[106:107], v[8:9] op_sel_hi:[1,0]
    v_pk_mul_f32 v[60:61], v[108:109], v[8:9] op_sel_hi:[1,0]
    ds_read_b64_tr_b16 v[134:135], v17 offset:2048
    v_pk_mul_f32 v[62:63], v[110:111], v[8:9] op_sel_hi:[1,0]
    v_exp_f32_e64 v48, v48 clamp
    ds_read_b64_tr_b16 v[136:137], v16 offset:4096
    v_exp_f32_e64 v49, v49 clamp
    v_exp_f32_e64 v50, v50 clamp
    ds_read_b64_tr_b16 v[138:139], v16 offset:6144
    v_exp_f32_e64 v51, v51 clamp
    v_exp_f32_e64 v52, v52 clamp
    ds_read_b64_tr_b16 v[140:141], v17 offset:4096
    v_exp_f32_e64 v53, v53 clamp
    v_exp_f32_e64 v54, v54 clamp
    ds_read_b64_tr_b16 v[142:143], v17 offset:6144
    v_exp_f32_e64 v55, v55 clamp
    v_exp_f32_e64 v56, v56 clamp
    ds_read_b64_tr_b16 v[144:145], v16 offset:8192
    v_exp_f32_e64 v57, v57 clamp
    v_exp_f32_e64 v58, v58 clamp
    ds_read_b64_tr_b16 v[146:147], v16 offset:10240
    v_exp_f32_e64 v59, v59 clamp
    v_exp_f32_e64 v60, v60 clamp
    ds_read_b64_tr_b16 v[148:149], v17 offset:8192
    v_exp_f32_e64 v61, v61 clamp
    v_exp_f32_e64 v62, v62 clamp
    ds_read_b64_tr_b16 v[150:151], v17 offset:10240
    v_exp_f32_e64 v63, v63 clamp
    v_max_f32 v96, 0, v96
    ds_read_b64_tr_b16 v[152:153], v16 offset:12288
    v_max_f32 v97, 0, v97
    v_max_f32 v98, 0, v98
    ds_read_b64_tr_b16 v[154:155], v16 offset:14336
    v_max_f32 v99, 0, v99
    v_max_f32 v100, 0, v100
    ds_read_b64_tr_b16 v[156:157], v17 offset:12288
    v_max_f32 v101, 0, v101
    v_max_f32 v102, 0, v102
    ds_read_b64_tr_b16 v[158:159], v17 offset:14336
    v_max_f32 v103, 0, v103
    v_max_f32 v104, 0, v104
    ds_read_b64_tr_b16 v[160:161], v16 offset:32768
    v_max_f32 v105, 0, v105
    v_max_f32 v106, 0, v106
    ds_read_b64_tr_b16 v[162:163], v16 offset:34816
    v_max_f32 v107, 0, v107
    v_max_f32 v108, 0, v108
    ds_read_b64_tr_b16 v[164:165], v17 offset:32768
    v_max_f32 v109, 0, v109
    v_max_f32 v110, 0, v110
    ds_read_b64_tr_b16 v[166:167], v17 offset:34816
    v_max_f32 v111, 0, v111
    v_pk_add_f32 v[48:49], v[48:49], v[8:9] op_sel:[0,1] op_sel_hi:[1,1]
    ds_read_b64_tr_b16 v[168:169], v16 offset:36864
    v_pk_add_f32 v[50:51], v[50:51], v[8:9] op_sel:[0,1] op_sel_hi:[1,1]
    v_pk_add_f32 v[52:53], v[52:53], v[8:9] op_sel:[0,1] op_sel_hi:[1,1]
    ds_read_b64_tr_b16 v[170:171], v16 offset:38912
    v_pk_add_f32 v[54:55], v[54:55], v[8:9] op_sel:[0,1] op_sel_hi:[1,1]
    v_pk_add_f32 v[56:57], v[56:57], v[8:9] op_sel:[0,1] op_sel_hi:[1,1]
    ds_read_b64_tr_b16 v[172:173], v17 offset:36864
    v_pk_add_f32 v[58:59], v[58:59], v[8:9] op_sel:[0,1] op_sel_hi:[1,1]
    v_pk_add_f32 v[60:61], v[60:61], v[8:9] op_sel:[0,1] op_sel_hi:[1,1]
    ds_read_b64_tr_b16 v[174:175], v17 offset:38912
    v_pk_add_f32 v[62:63], v[62:63], v[8:9] op_sel:[0,1] op_sel_hi:[1,1]
    v_pk_add_f32 v[96:97], v[96:97], v[48:49]
    ds_read_b64_tr_b16 v[176:177], v16 offset:40960
    v_pk_add_f32 v[98:99], v[98:99], v[50:51]
    v_pk_add_f32 v[100:101], v[100:101], v[52:53]
    ds_read_b64_tr_b16 v[178:179], v16 offset:43008
    v_pk_add_f32 v[102:103], v[102:103], v[54:55]
    v_pk_add_f32 v[104:105], v[104:105], v[56:57]
    ds_read_b64_tr_b16 v[180:181], v17 offset:40960
    v_pk_add_f32 v[106:107], v[106:107], v[58:59]
    v_pk_add_f32 v[108:109], v[108:109], v[60:61]
    ds_read_b64_tr_b16 v[182:183], v17 offset:43008
    v_pk_add_f32 v[110:111], v[110:111], v[62:63]
    v_cvt_pk_bf16_f32 v32, v96, v97
    ds_read_b64_tr_b16 v[184:185], v16 offset:45056
    v_cvt_pk_bf16_f32 v33, v98, v99
    v_cvt_pk_bf16_f32 v34, v100, v101
    ds_read_b64_tr_b16 v[186:187], v16 offset:47104
    v_cvt_pk_bf16_f32 v35, v102, v103
    v_cvt_pk_bf16_f32 v36, v104, v105
    ds_read_b64_tr_b16 v[188:189], v17 offset:45056
    v_cvt_pk_bf16_f32 v37, v106, v107
    v_cvt_pk_bf16_f32 v38, v108, v109
    ds_read_b64_tr_b16 v[190:191], v17 offset:47104
    v_cvt_pk_bf16_f32 v39, v110, v111
    v_mov_b32 v26, 0x3f80
    v_mov_b32 v27, 0x3f800000
    s_waitcnt vmcnt(8)
    v_max3_u32 v56, v112, v113, v114
    v_max3_u32 v56, v56, v115, v116
    v_max3_u32 v56, v56, v117, v118
    v_max3_u32 v56, v56, v119, v120
    v_max3_u32 v56, v56, v121, v122
    v_max3_u32 v56, v56, v123, v124
    v_max3_u32 v56, v56, v125, v126
    v_max_u32 v56, v56, v127
    v_cmp_eq_u32 vcc, -1, v56
    s_cbranch_vccnz Lgr_62
Lgo_63:
    v_dot2_f32_bf16 v48, v112, v26, 0
    v_dot2_f32_bf16 v49, v112, v27, 0
    v_dot2_f32_bf16 v50, v113, v26, 0
    v_dot2_f32_bf16 v51, v113, v27, 0
    v_dot2_f32_bf16 v52, v114, v26, 0
    v_dot2_f32_bf16 v53, v114, v27, 0
    v_dot2_f32_bf16 v54, v115, v26, 0
    v_dot2_f32_bf16 v55, v115, v27, 0
    v_dot2_f32_bf16 v48, v116, v26, v48
    v_dot2_f32_bf16 v49, v116, v27, v49
    v_dot2_f32_bf16 v50, v117, v26, v50
    v_dot2_f32_bf16 v51, v117, v27, v51
    v_dot2_f32_bf16 v52, v118, v26, v52
    v_dot2_f32_bf16 v53, v118, v27, v53
    v_dot2_f32_bf16 v54, v119, v26, v54
    v_dot2_f32_bf16 v55, v119, v27, v55
    v_dot2_f32_bf16 v48, v120, v26, v48
    v_dot2_f32_bf16 v49, v120, v27, v49
    v_dot2_f32_bf16 v50, v121, v26, v50
    v_dot2_f32_bf16 v51, v121, v27, v51
    v_dot2_f32_bf16 v52, v122, v26, v52
    v_dot2_f32_bf16 v53, v122, v27, v53
    v_dot2_f32_bf16 v54, v123, v26, v54
    v_dot2_f32_bf16 v55, v123, v27, v55
    v_dot2_f32_bf16 v48, v124, v26, v48
    v_dot2_f32_bf16 v49, v124, v27, v49
    v_dot2_f32_bf16 v50, v125, v26, v50
    v_dot2_f32_bf16 v51, v125, v27, v51
    v_dot2_f32_bf16 v52, v126, v26, v52
    v_dot2_f32_bf16 v53, v126, v27, v53
    v_dot2_f32_bf16 v54, v127, v26, v54
    v_dot2_f32_bf16 v55, v127, v27, v55
    s_lshl_b32 s54, s44, 11
    s_add_u32 s54, s54, 0x20000
    v_add_u32 v30, s54, v18
    ds_write_b128 v30, v[48:51] offset:0
    ds_write_b128 v30, v[52:55] offset:1024
    s_cmp_ge_u32 s44, 7
    s_cbranch_scc1 Lout_65
Lback_66:
    s_waitcnt vmcnt(0)
    s_waitcnt lgkmcnt(0)
    s_barrier
    s_cmp_eq_u32 s44, 5
    s_cbranch_scc1 Lout_67
Lback_68:
    s_lshl_b32 s54, s45, 13
    s_add_u32 s54, s54, 0x20000
    v_add_u32 v30, s54, v18
    ds_read_b128 v[64:67], v30 offset:0
    ds_read_b128 v[68:71], v30 offset:2048
    ds_read_b128 v[72:75], v30 offset:4096
    ds_read_b128 v[76:79], v30 offset:6144
    ds_read_b128 v[80:83], v30 offset:1024
    ds_read_b128 v[84:87], v30 offset:3072
    ds_read_b128 v[88:91], v30 offset:5120
    ds_read_b128 v[92:95], v30 offset:7168
    v_lshrrev_b32 v31, 4, v0
    v_lshlrev_b32 v31, 4, v31
    s_lshl_b32 s54, s45, 7
    s_add_u32 s54, s54, 0x24000
    v_add_u32 v31, s54, v31
    ds_read_b128 v[48:51], v31 offset:0
    ds_read_b128 v[52:55], v31 offset:64
    s_waitcnt lgkmcnt(2)
    v_add_f32 v64, v64, v68
    v_add_f32 v65, v65, v69
    v_add_f32 v66, v66, v70
    v_add_f32 v67, v67, v71
    v_add_f32 v72, v72, v76
    v_add_f32 v73, v73, v77
    v_add_f32 v74, v74, v78
    v_add_f32 v75, v75, v79
    v_add_f32 v80, v80, v84
    v_add_f32 v81, v81, v85
    v_add_f32 v82, v82, v86
    v_add_f32 v83, v83, v87
    v_add_f32 v88, v88, v92
    v_add_f32 v89, v89, v93
    v_add_f32 v90, v90, v94
    v_add_f32 v91, v91, v95
    v_add_f32 v64, v64, v72
    v_add_f32 v65, v65, v73
    v_add_f32 v66, v66, v74
    v_add_f32 v67, v67, v75
    v_add_f32 v80, v80, v88
    v_add_f32 v81, v81, v89
    v_add_f32 v82, v82, v90
    v_add_f32 v83, v83, v91
    v_cvt_pk_bf16_f32 v96, v64, v65
    v_cvt_pk_bf16_f32 v97, v66, v67
    v_cvt_pk_bf16_f32 v100, v80, v81
    v_cvt_pk_bf16_f32 v101, v82, v83
    s_waitcnt lgkmcnt(0)
    v_cvt_pk_bf16_f32 v104, v48, v49
    v_cvt_pk_bf16_f32 v105, v50, v51
    v_cvt_pk_bf16_f32 v108, v52, v53
    v_cvt_pk_bf16_f32 v109, v54, v55
    v_mfma_f32_16x16x16_bf16 v[80:83], v[104:105], v[32:33], 0
    v_mfma_f32_16x16x16_bf16 v[84:87], v[104:105], v[34:35], 0
    v_mfma_f32_16x16x16_bf16 v[88:91], v[108:109], v[36:37], 0
    v_mfma_f32_16x16x16_bf16 v[92:95], v[108:109], v[38:39], 0
    v_mfma_f32_16x16x16_bf16 v[64:67], v[96:97], v[32:33], 0
    v_mfma_f32_16x16x16_bf16 v[68:71], v[96:97], v[34:35], 0
    v_mfma_f32_16x16x16_bf16 v[72:75], v[100:101], v[36:37], 0
    v_mfma_f32_16x16x16_bf16 v[76:79], v[100:101], v[38:39], 0
    s_nop 0
    v_add_f32 v80, 0x358637bd, v80
    v_add_f32 v84, 0x358637bd, v84
    v_add_f32 v88, 0x358637bd, v88
    v_add_f32 v92, 0x358637bd, v92
    v_rcp_f32 v80, v80
    v_rcp_f32 v84, v84
    v_rcp_f32 v88, v88
    v_rcp_f32 v92, v92
    v_mul_f32 v64, v64, v80
    v_mul_f32 v65, v65, v80
    v_mul_f32 v66, v66, v80
    v_mul_f32 v67, v67, v80
    v_mul_f32 v68, v68, v84
    v_mul_f32 v69, v69, v84
    v_mul_f32 v70, v70, v84
    v_mul_f32 v71, v71, v84
    v_mul_f32 v72, v72, v88
    v_mul_f32 v73, v73, v88
    v_mul_f32 v74, v74, v88
    v_mul_f32 v75, v75, v88
    v_mul_f32 v76, v76, v92
    v_mul_f32 v77, v77, v92
    v_mul_f32 v78, v78, v92
    v_mul_f32 v79, v79, v92
    v_cvt_pk_bf16_f32 v112, v64, v65
    v_cvt_pk_bf16_f32 v113, v66, v67
    v_cvt_pk_bf16_f32 v116, v68, v69
    v_cvt_pk_bf16_f32 v117, v70, v71
    v_cvt_pk_bf16_f32 v114, v72, v73
    v_cvt_pk_bf16_f32 v115, v74, v75
    v_cvt_pk_bf16_f32 v118, v76, v77
    v_cvt_pk_bf16_f32 v119, v78, v79
    s_mov_b32 s55, 0x8000
    buffer_store_dwordx4 v[112:115], v12, s[24:27], 0 offen sc1
    buffer_store_dwordx4 v[116:119], v12, s[24:27], s55 offen sc1
    s_barrier
    s_cmp_eq_u32 s44, 5
    s_cbranch_scc1 Lout_69
Lback_70:
    s_add_u32 m0, s76, 98304
    s_nop 0
    buffer_load_dwordx4 v6, s[16:19], s83 offen lds
    s_add_u32 m0, s76, 99328
    s_nop 0
    buffer_load_dwordx4 v7, s[16:19], s83 offen lds
    s_add_u32 m0, s76, 114688
    s_nop 0
    buffer_load_dwordx4 v6, s[20:23], s83 offen lds
    s_add_u32 m0, s76, 115712
    s_nop 0
    buffer_load_dwordx4 v7, s[20:23], s83 offen lds
L_p3:
    s_lshl_b32 s54, s47, 2
    s_and_b32 s55, s44, 1
    s_lshl_b32 s55, s55, 1
    s_add_u32 s54, s54, s55
    s_lshl_b32 s54, s54, 5
    s_lshl_b32 s55, s45, 4
    s_add_u32 s54, s54, s55
    s_bfe_u32 s55, s44, 0x10001
    s_add_u32 s54, s54, s55
    s_lshl_b32 s54, s54, 10
    s_add_u32 s54, s54, 0x100000
    v_add_u32 v20, s54, v18
    v_add_u32 v21, 0x8000, v20
    s_lshr_b32 s60, s80, 5
    s_lshr_b32 s61, s80, 5
    s_add_u32 s61, s61, 2048
    s_lshr_b32 s62, s81, 5
    s_lshr_b32 s63, s81, 5
    s_add_u32 s63, s63, 2048
    s_lshr_b32 s64, s82, 5
    s_lshr_b32 s65, s82, 5
    s_add_u32 s65, s65, 2048
    s_lshr_b32 s66, s83, 5
    s_lshr_b32 s67, s83, 5
    s_add_u32 s67, s67, 2048
    s_lshl_b32 s54, s47, 6
    s_bfe_u32 s55, s44, 0x10001
    s_lshl_b32 s55, s55, 5
    s_add_u32 s54, s54, s55
    s_lshl_b32 s55, s45, 4
    s_add_u32 s54, s54, s55
    s_lshl_b32 s54, s54, 2
    s_add_u32 s54, s54, 0x4000
    v_and_b32 v24, 15, v0
    v_lshlrev_b32 v24, 2, v24
    v_add_u32 v24, s54, v24
    s_lshl_b32 s54, s44, 11
    s_add_u32 s54, s54, 0x20000
    v_add_u32 v40, s54, v18
    s_xor_b32 s55, s44, 4
    s_lshl_b32 s55, s55, 11
    s_add_u32 s55, s55, 0x20000
    v_add_u32 v41, s55, v18
    s_lshl_b32 s55, s44, 2
    s_add_u32 s55, s55, 0x24000
    v_mov_b32 v42, s55
    v_mov_b32 v43, 0x24000
    s_lshl_b32 s54, s47, 6
    s_bfe_u32 s55, s44, 0x10001
    s_lshl_b32 s55, s55, 5
    s_add_u32 s54, s54, s55
    s_lshl_b32 s55, s45, 4
    s_add_u32 s54, s54, s55
    v_and_b32 v46, 15, v0
    v_add_u32 v46, s54, v46
    v_lshlrev_b32 v46, 10, v46
    v_lshrrev_b32 v31, 4, v0
    v_and_b32 v26, 1, v31
    v_lshrrev_b32 v31, 1, v31
    v_lshlrev_b32 v26, 5, v26
    v_lshl_add_u32 v26, v31, 4, v26
    s_lshl_b32 s54, s48, 7
    s_and_b32 s55, s44, 1
    s_lshl_b32 s55, s55, 6
    s_add_u32 s54, s54, s55
    v_add3_u32 v46, v46, v26, s54
    s_cmp_eq_u32 s44, 5
    s_cbranch_scc1 Lout_71
Lback_72:
    s_waitcnt vmcnt(0)
    s_barrier
    v_add_u32 v26, 65536, v16
    v_add_u32 v27, 65536, v17
    ds_read_b64_tr_b16 v[192:193], v26 offset:0
    ds_read_b64_tr_b16 v[194:195], v26 offset:2048
    ds_read_b64_tr_b16 v[196:197], v27 offset:0
    ds_read_b64_tr_b16 v[198:199], v27 offset:2048
    ds_read_b64_tr_b16 v[200:201], v26 offset:4096
    ds_read_b64_tr_b16 v[202:203], v26 offset:6144
    ds_read_b64_tr_b16 v[204:205], v27 offset:4096
    ds_read_b64_tr_b16 v[206:207], v27 offset:6144
    ds_read_b64_tr_b16 v[208:209], v26 offset:8192
    ds_read_b64_tr_b16 v[210:211], v26 offset:10240
    ds_read_b64_tr_b16 v[212:213], v27 offset:8192
    ds_read_b64_tr_b16 v[214:215], v27 offset:10240
    ds_read_b64_tr_b16 v[216:217], v26 offset:12288
    ds_read_b64_tr_b16 v[218:219], v26 offset:14336
    ds_read_b64_tr_b16 v[220:221], v27 offset:12288
    ds_read_b64_tr_b16 v[222:223], v27 offset:14336
    v_add_u32 v26, 98304, v16
    v_add_u32 v27, 98304, v17
    ds_read_b64_tr_b16 v[224:225], v26 offset:0
    ds_read_b64_tr_b16 v[226:227], v26 offset:2048
    ds_read_b64_tr_b16 v[228:229], v27 offset:0
    ds_read_b64_tr_b16 v[230:231], v27 offset:2048
    ds_read_b64_tr_b16 v[232:233], v26 offset:4096
    ds_read_b64_tr_b16 v[234:235], v26 offset:6144
    ds_read_b64_tr_b16 v[236:237], v27 offset:4096
    ds_read_b64_tr_b16 v[238:239], v27 offset:6144
    ds_read_b64_tr_b16 v[240:241], v26 offset:8192
    ds_read_b64_tr_b16 v[242:243], v26 offset:10240
    ds_read_b64_tr_b16 v[244:245], v27 offset:8192
    ds_read_b64_tr_b16 v[246:247], v27 offset:10240
    ds_read_b64_tr_b16 v[248:249], v26 offset:12288
    ds_read_b64_tr_b16 v[250:251], v26 offset:14336
    ds_read_b64_tr_b16 v[252:253], v27 offset:12288
    ds_read_b64_tr_b16 v[254:255], v27 offset:14336
    s_cmp_eq_u32 s44, 5
    s_cbranch_scc1 Lout_75
Lback_76:
    s_waitcnt lgkmcnt(0)
    s_barrier
    s_mov_b32 s53, 0
    s_add_u32 m0, s76, 0
    s_nop 0
    buffer_load_dwordx4 v20, s[24:27], s60 offen sc1 lds
    s_add_u32 m0, s76, 1024
    s_nop 0
    buffer_load_dwordx4 v21, s[24:27], s60 offen sc1 lds
    s_add_u32 m0, s76, 16384
    s_nop 0
    buffer_load_dwordx4 v20, s[24:27], s61 offen sc1 lds
    s_add_u32 m0, s76, 17408
    s_nop 0
    buffer_load_dwordx4 v21, s[24:27], s61 offen sc1 lds
    s_add_u32 m0, s76, 32768
    s_nop 0
    buffer_load_dwordx4 v20, s[24:27], s62 offen sc1 lds
    s_add_u32 m0, s76, 33792
    s_nop 0
    buffer_load_dwordx4 v21, s[24:27], s62 offen sc1 lds
    buffer_load_dword v25, v24, s[24:27], 0 offen sc1
L_p3r:
    s_lshl_b32 s54, s45, 13
    s_bfe_u32 s55, s44, 0x10001
    s_lshl_b32 s55, s55, 11
    s_add_u32 s54, s54, s55
    s_lshl_b32 s55, s45, 10
    s_add_u32 s54, s54, s55
    v_add_u32 v26, s54, v18
    v_xor_b32 v27, 0x400, v26
    v_add_u32 v28, 0x10000, v26
    v_add_u32 v29, 0x10000, v27
    s_waitcnt vmcnt(5)
    s_barrier
    s_waitcnt lgkmcnt(0)
    ds_read_b128 v[64:67], v26 offset:0
    ds_read_b128 v[68:71], v27 offset:0
    ds_read_b128 v[72:75], v26 offset:4096
    ds_read_b128 v[76:79], v27 offset:4096
    s_waitcnt lgkmcnt(3)
    v_mfma_f32_16x16x32_bf16 v[96:99], v[128:131], v[64:67], 0
    s_waitcnt vmcnt(3)
    s_barrier
    ds_read_b128 v[80:83], v26 offset:16384
    v_mfma_f32_16x16x32_bf16 v[100:103], v[132:135], v[64:67], 0
    ds_read_b128 v[84:87], v27 offset:16384
    s_waitcnt lgkmcnt(4)
    v_mfma_f32_16x16x32_bf16 v[104:107], v[128:131], v[68:71], 0
    ds_read_b128 v[88:91], v26 offset:20480
    s_add_u32 m0, s76, 49152
    s_nop 0
    buffer_load_dwordx4 v20, s[24:27], s63 offen sc1 lds
    v_mfma_f32_16x16x32_bf16 v[108:111], v[132:135], v[68:71], 0
    ds_read_b128 v[92:95], v27 offset:20480
    s_waitcnt lgkmcnt(5)
    v_mfma_f32_16x16x32_bf16 v[96:99], v[136:139], v[72:75], v[96:99]
    v_mfma_f32_16x16x32_bf16 v[100:103], v[140:143], v[72:75], v[100:103]
    s_add_u32 m0, s76, 50176
    s_nop 0
    buffer_load_dwordx4 v21, s[24:27], s63 offen sc1 lds
    s_waitcnt lgkmcnt(4)
    v_mfma_f32_16x16x32_bf16 v[104:107], v[136:139], v[76:79], v[104:107]
    v_mfma_f32_16x16x32_bf16 v[108:111], v[140:143], v[76:79], v[108:111]
    v_max3_u32 v56, v64, v65, v66
    v_max3_u32 v56, v56, v67, v68
    v_max3_u32 v56, v56, v69, v70
    v_max3_u32 v56, v56, v71, v72
    v_max3_u32 v56, v56, v73, v74
    v_max3_u32 v56, v56, v75, v76
    v_max3_u32 v56, v56, v77, v78
    v_max_u32 v56, v56, v79
    s_waitcnt lgkmcnt(3)
    v_mfma_f32_16x16x32_bf16 v[96:99], v[144:147], v[80:83], v[96:99]
    s_waitcnt vmcnt(3)
    s_barrier
    ds_read_b128 v[64:67], v26 offset:32768
    v_mfma_f32_16x16x32_bf16 v[100:103], v[148:151], v[80:83], v[100:103]
    ds_read_b128 v[68:71], v27 offset:32768
    s_waitcnt lgkmcnt(4)
    v_mfma_f32_16x16x32_bf16 v[104:107], v[144:147], v[84:87], v[104:107]
    ds_read_b128 v[72:75], v26 offset:36864
    s_add_u32 m0, s76, 65536
    s_nop 0
    buffer_load_dwordx4 v20, s[24:27], s64 offen sc1 lds
    v_mfma_f32_16x16x32_bf16 v[108:111], v[148:151], v[84:87], v[108:111]
    ds_read_b128 v[76:79], v27 offset:36864
    s_waitcnt lgkmcnt(5)
    v_mfma_f32_16x16x32_bf16 v[96:99], v[152:155], v[88:91], v[96:99]
    v_mfma_f32_16x16x32_bf16 v[100:103], v[156:159], v[88:91], v[100:103]
    s_add_u32 m0, s76, 66560
    s_nop 0
    buffer_load_dwordx4 v21, s[24:27], s64 offen sc1 lds
    s_waitcnt lgkmcnt(4)
    v_mfma_f32_16x16x32_bf16 v[104:107], v[152:155], v[92:95], v[104:107]
    v_mfma_f32_16x16x32_bf16 v[108:111], v[156:159], v[92:95], v[108:111]
    v_max3_u32 v56, v56, v80, v81
    v_max3_u32 v56, v56, v82, v83
    v_max3_u32 v56, v56, v84, v85
    v_max3_u32 v56, v56, v86, v87
    v_max3_u32 v56, v56, v88, v89
    v_max3_u32 v56, v56, v90, v91
    v_max3_u32 v56, v56, v92, v93
    v_max3_u32 v56, v56, v94, v95
    s_waitcnt lgkmcnt(3)
    v_mfma_f32_16x16x32_bf16 v[96:99], v[160:163], v[64:67], v[96:99]
    s_waitcnt vmcnt(2)
    s_barrier
    ds_read_b128 v[80:83], v26 offset:49152
    v_mfma_f32_16x16x32_bf16 v[100:103], v[164:167], v[64:67], v[100:103]
    ds_read_b128 v[84:87], v27 offset:49152
    s_waitcnt lgkmcnt(4)
    v_mfma_f32_16x16x32_bf16 v[104:107], v[160:163], v[68:71], v[104:107]
    ds_read_b128 v[88:91], v26 offset:53248
    s_add_u32 m0, s76, 81920
    s_nop 0
    buffer_load_dwordx4 v20, s[24:27], s65 offen sc1 lds
    v_mfma_f32_16x16x32_bf16 v[108:111], v[164:167], v[68:71], v[108:111]
    ds_read_b128 v[92:95], v27 offset:53248
    s_waitcnt lgkmcnt(5)
    v_mfma_f32_16x16x32_bf16 v[96:99], v[168:171], v[72:75], v[96:99]
    v_mfma_f32_16x16x32_bf16 v[100:103], v[172:175], v[72:75], v[100:103]
    s_add_u32 m0, s76, 82944
    s_nop 0
    buffer_load_dwordx4 v21, s[24:27], s65 offen sc1 lds
    s_waitcnt lgkmcnt(4)
    v_mfma_f32_16x16x32_bf16 v[104:107], v[168:171], v[76:79], v[104:107]
    v_mfma_f32_16x16x32_bf16 v[108:111], v[172:175], v[76:79], v[108:111]
    v_max3_u32 v56, v56, v64, v65
    v_max3_u32 v56, v56, v66, v67
    v_max3_u32 v56, v56, v68, v69
    v_max3_u32 v56, v56, v70, v71
    v_max3_u32 v56, v56, v72, v73
    v_max3_u32 v56, v56, v74, v75
    v_max3_u32 v56, v56, v76, v77
    v_max3_u32 v56, v56, v78, v79
    s_waitcnt lgkmcnt(3)
    v_mfma_f32_16x16x32_bf16 v[96:99], v[176:179], v[80:83], v[96:99]
    s_waitcnt vmcnt(2)
    s_barrier
    ds_read_b128 v[64:67], v28 offset:0
    v_mfma_f32_16x16x32_bf16 v[100:103], v[180:183], v[80:83], v[100:103]
    ds_read_b128 v[68:71], v29 offset:0
    s_waitcnt lgkmcnt(4)
    v_mfma_f32_16x16x32_bf16 v[104:107], v[176:179], v[84:87], v[104:107]
    ds_read_b128 v[72:75], v28 offset:4096
    s_add_u32 m0, s76, 98304
    s_nop 0
    buffer_load_dwordx4 v20, s[24:27], s66 offen sc1 lds
    v_mfma_f32_16x16x32_bf16 v[108:111], v[180:183], v[84:87], v[108:111]
    ds_read_b128 v[76:79], v29 offset:4096
    s_waitcnt lgkmcnt(5)
    v_mfma_f32_16x16x32_bf16 v[96:99], v[184:187], v[88:91], v[96:99]
    v_mfma_f32_16x16x32_bf16 v[100:103], v[188:191], v[88:91], v[100:103]
    s_add_u32 m0, s76, 99328
    s_nop 0
    buffer_load_dwordx4 v21, s[24:27], s66 offen sc1 lds
    s_waitcnt lgkmcnt(4)
    v_mfma_f32_16x16x32_bf16 v[104:107], v[184:187], v[92:95], v[104:107]
    v_mfma_f32_16x16x32_bf16 v[108:111], v[188:191], v[92:95], v[108:111]
    v_max3_u32 v56, v56, v80, v81
    v_max3_u32 v56, v56, v82, v83
    v_max3_u32 v56, v56, v84, v85
    v_max3_u32 v56, v56, v86, v87
    v_max3_u32 v56, v56, v88, v89
    v_max3_u32 v56, v56, v90, v91
    v_max3_u32 v56, v56, v92, v93
    v_max3_u32 v56, v56, v94, v95
    s_waitcnt vmcnt(8)
    v_max_u32 v56, v56, v25
    v_sub_f32 v44, 1.0, v25
    s_cmp_eq_u32 s45, 0
    s_cselect_b64 vcc, -1, 0
    v_cndmask_b32 v45, v44, v25, vcc
    v_cndmask_b32 v44, v25, v44, vcc
    s_waitcnt lgkmcnt(3)
    v_mfma_f32_16x16x32_bf16 v[96:99], v[192:195], v[64:67], v[96:99]
    s_waitcnt vmcnt(2)
    s_barrier
    ds_read_b128 v[80:83], v28 offset:16384
    v_mfma_f32_16x16x32_bf16 v[100:103], v[196:199], v[64:67], v[100:103]
    ds_read_b128 v[84:87], v29 offset:16384
    s_waitcnt lgkmcnt(4)
    v_mfma_f32_16x16x32_bf16 v[104:107], v[192:195], v[68:71], v[104:107]
    ds_read_b128 v[88:91], v28 offset:20480
    s_add_u32 m0, s76, 114688
    s_nop 0
    buffer_load_dwordx4 v20, s[24:27], s67 offen sc1 lds
    v_mfma_f32_16x16x32_bf16 v[108:111], v[196:199], v[68:71], v[108:111]
    ds_read_b128 v[92:95], v29 offset:20480
    s_waitcnt lgkmcnt(5)
    v_mfma_f32_16x16x32_bf16 v[96:99], v[200:203], v[72:75], v[96:99]
    v_mfma_f32_16x16x32_bf16 v[100:103], v[204:207], v[72:75], v[100:103]
    s_add_u32 m0, s76, 115712
    s_nop 0
    buffer_load_dwordx4 v21, s[24:27], s67 offen sc1 lds
    s_waitcnt lgkmcnt(4)
    v_mfma_f32_16x16x32_bf16 v[104:107], v[200:203], v[76:79], v[104:107]
    v_mfma_f32_16x16x32_bf16 v[108:111], v[204:207], v[76:79], v[108:111]
    v_max3_u32 v56, v56, v64, v65
    v_max3_u32 v56, v56, v66, v67
    v_max3_u32 v56, v56, v68, v69
    v_max3_u32 v56, v56, v70, v71
    v_max3_u32 v56, v56, v72, v73
    v_max3_u32 v56, v56, v74, v75
    v_max3_u32 v56, v56, v76, v77
    v_max3_u32 v56, v56, v78, v79
    s_waitcnt lgkmcnt(3)
    v_mfma_f32_16x16x32_bf16 v[96:99], v[208:211], v[80:83], v[96:99]
    s_waitcnt vmcnt(2)
    s_barrier
    ds_read_b128 v[64:67], v28 offset:32768
    v_mfma_f32_16x16x32_bf16 v[100:103], v[212:215], v[80:83], v[100:103]
    ds_read_b128 v[68:71], v29 offset:32768
    s_waitcnt lgkmcnt(4)
    v_mfma_f32_16x16x32_bf16 v[104:107], v[208:211], v[84:87], v[104:107]
    ds_read_b128 v[72:75], v28 offset:36864
    v_mfma_f32_16x16x32_bf16 v[108:111], v[212:215], v[84:87], v[108:111]
    ds_read_b128 v[76:79], v29 offset:36864
    s_waitcnt lgkmcnt(5)
    v_mfma_f32_16x16x32_bf16 v[96:99], v[216:219], v[88:91], v[96:99]
    v_mfma_f32_16x16x32_bf16 v[100:103], v[220:223], v[88:91], v[100:103]
    s_waitcnt lgkmcnt(4)
    v_mfma_f32_16x16x32_bf16 v[104:107], v[216:219], v[92:95], v[104:107]
    v_mfma_f32_16x16x32_bf16 v[108:111], v[220:223], v[92:95], v[108:111]
    v_max3_u32 v56, v56, v80, v81
    v_max3_u32 v56, v56, v82, v83
    v_max3_u32 v56, v56, v84, v85
    v_max3_u32 v56, v56, v86, v87
    v_max3_u32 v56, v56, v88, v89
    v_max3_u32 v56, v56, v90, v91
    v_max3_u32 v56, v56, v92, v93
    v_max3_u32 v56, v56, v94, v95
    s_waitcnt lgkmcnt(3)
    v_mfma_f32_16x16x32_bf16 v[96:99], v[224:227], v[64:67], v[96:99]
    s_waitcnt vmcnt(0)
    s_barrier
    ds_read_b128 v[80:83], v28 offset:49152
    v_mfma_f32_16x16x32_bf16 v[100:103], v[228:231], v[64:67], v[100:103]
    ds_read_b128 v[84:87], v29 offset:49152
    s_waitcnt lgkmcnt(4)
    v_mfma_f32_16x16x32_bf16 v[104:107], v[224:227], v[68:71], v[104:107]
    ds_read_b128 v[88:91], v28 offset:53248
    v_mfma_f32_16x16x32_bf16 v[108:111], v[228:231], v[68:71], v[108:111]
    ds_read_b128 v[92:95], v29 offset:53248
    s_waitcnt lgkmcnt(5)
    v_mfma_f32_16x16x32_bf16 v[96:99], v[232:235], v[72:75], v[96:99]
    v_mfma_f32_16x16x32_bf16 v[100:103], v[236:239], v[72:75], v[100:103]
    s_waitcnt lgkmcnt(4)
    v_mfma_f32_16x16x32_bf16 v[104:107], v[232:235], v[76:79], v[104:107]
    v_mfma_f32_16x16x32_bf16 v[108:111], v[236:239], v[76:79], v[108:111]
    v_max3_u32 v56, v56, v64, v65
    v_max3_u32 v56, v56, v66, v67
    v_max3_u32 v56, v56, v68, v69
    v_max3_u32 v56, v56, v70, v71
    v_max3_u32 v56, v56, v72, v73
    v_max3_u32 v56, v56, v74, v75
    v_max3_u32 v56, v56, v76, v77
    v_max3_u32 v56, v56, v78, v79
    s_waitcnt lgkmcnt(3)
    v_mfma_f32_16x16x32_bf16 v[96:99], v[240:243], v[80:83], v[96:99]
    v_mfma_f32_16x16x32_bf16 v[100:103], v[244:247], v[80:83], v[100:103]
    s_waitcnt lgkmcnt(2)
    v_mfma_f32_16x16x32_bf16 v[104:107], v[240:243], v[84:87], v[104:107]
    v_mfma_f32_16x16x32_bf16 v[108:111], v[244:247], v[84:87], v[108:111]
    s_waitcnt lgkmcnt(1)
    v_mfma_f32_16x16x32_bf16 v[96:99], v[248:251], v[88:91], v[96:99]
    v_mfma_f32_16x16x32_bf16 v[100:103], v[252:255], v[88:91], v[100:103]
    s_waitcnt lgkmcnt(0)
    v_mfma_f32_16x16x32_bf16 v[104:107], v[248:251], v[92:95], v[104:107]
    v_mfma_f32_16x16x32_bf16 v[108:111], v[252:255], v[92:95], v[108:111]
    v_max3_u32 v56, v56, v80, v81
    v_max3_u32 v56, v56, v82, v83
    v_max3_u32 v56, v56, v84, v85
    v_max3_u32 v56, v56, v86, v87
    v_max3_u32 v56, v56, v88, v89
    v_max3_u32 v56, v56, v90, v91
    v_max3_u32 v56, v56, v92, v93
    v_max3_u32 v56, v56, v94, v95
    s_lshl_b32 s54, s2, 3
    s_add_u32 s54, s54, s44
    s_cmp_eq_u32 s54, 5
    s_cbranch_scc1 Lout_79
Lback_80:
    ds_write_b128 v40, v[104:107] offset:0
    ds_write_b128 v40, v[108:111] offset:1024
    v_cmp_eq_u32 vcc, -1, v56
    s_nop 0
    s_cmp_lg_u64 vcc, 0
    s_cselect_b32 s54, 1, 0
    v_mov_b32 v27, s54
    s_mov_b64 exec, 1
    ds_write_b32 v42, v27
    s_mov_b64 exec, -1
    v_mul_f32 v96, v45, v96
    v_mul_f32 v97, v45, v97
    v_mul_f32 v98, v45, v98
    v_mul_f32 v99, v45, v99
    v_mul_f32 v100, v45, v100
    v_mul_f32 v101, v45, v101
    v_mul_f32 v102, v45, v102
    v_mul_f32 v103, v45, v103
    s_waitcnt lgkmcnt(0)
    s_barrier
    ds_read_b128 v[64:67], v41 offset:0
    ds_read_b128 v[68:71], v41 offset:1024
    ds_read_b128 v[72:75], v43
    ds_read_b128 v[76:79], v43 offset:16
    s_waitcnt lgkmcnt(2)
    v_fma_f32 v96, v44, v64, v96
    v_fma_f32 v97, v44, v65, v97
    v_fma_f32 v98, v44, v66, v98
    v_fma_f32 v99, v44, v67, v99
    v_fma_f32 v100, v44, v68, v100
    v_fma_f32 v101, v44, v69, v101
    v_fma_f32 v102, v44, v70, v102
    v_fma_f32 v103, v44, v71, v103
    v_cvt_pk_bf16_f32 v32, v96, v97
    v_cvt_pk_bf16_f32 v33, v98, v99
    v_cvt_pk_bf16_f32 v34, v100, v101
    v_cvt_pk_bf16_f32 v35, v102, v103
    s_waitcnt lgkmcnt(0)
    v_or3_b32 v72, v72, v73, v74
    v_or3_b32 v76, v76, v77, v78
    v_or3_b32 v72, v72, v75, v76
    v_or_b32 v72, v72, v79
    v_permlane16_swap_b32 v32, v34
    v_permlane16_swap_b32 v33, v35
    v_readfirstlane_b32 s54, v72
    s_nop 0
    s_cmp_lg_u32 s54, 0
    s_cbranch_scc1 Lre_82
Lok_81:
    buffer_store_dwordx4 v[32:35], v46, s[28:31], 0 offen
L_end:
    s_endpgm
Lout_5:
    s_lshl_b32 s54, s42, 3
    s_add_u32 s54, s54, s41
    s_lshl_b32 s54, s54, 4
    s_add_u32 s54, s54, s40
    s_lshl_b32 s54, s54, 3
    s_add_u32 s54, s54, 0x1000
    v_mov_b32 v30, s54
    v_mov_b32 v28, s50
    v_mov_b32 v29, s51
    s_mov_b64 exec, 1
    buffer_store_dwordx2 v[28:29], v30, s[24:27], 0 offen sc1
    s_mov_b64 exec, -1
    s_branch Lback_6
Lout_7:
    s_xor_b32 s54, s42, 1
    s_lshl_b32 s54, s54, 3
    s_add_u32 s54, s54, s41
    s_lshl_b32 s54, s54, 7
    s_add_u32 s54, s54, 0x1000
    v_and_b32 v30, 15, v0
    v_lshlrev_b32 v30, 3, v30
    v_add_u32 v30, s54, v30
    buffer_load_dwordx2 v[20:21], v30, s[24:27], 0 offen sc1
    s_branch Lback_8
Lout_11:
    s_waitcnt vmcnt(8)
    s_mov_b32 s57, 0
Lcp_14:
    v_cmp_eq_u64 vcc, s[50:51], v[20:21]
    s_nop 0
    s_cmp_eq_u64 vcc, -1
    s_cbranch_scc1 Lcc_13
    s_xor_b32 s54, s42, 1
    s_lshl_b32 s54, s54, 3
    s_add_u32 s54, s54, s41
    s_lshl_b32 s54, s54, 7
    s_add_u32 s54, s54, 0x1000
    v_and_b32 v30, 15, v0
    v_lshlrev_b32 v30, 3, v30
    v_add_u32 v30, s54, v30
    buffer_load_dwordx2 v[20:21], v30, s[24:27], 0 offen sc1
    s_add_u32 s57, s57, 1
    s_waitcnt vmcnt(0)
    s_cmp_lt_u32 s57, 0x40000
    s_cbranch_scc1 Lcp_14
Lcc_13:
    s_branch Lback_12
Lout_15:
    s_lshl_b32 s54, s40, 4
    s_lshl_b32 s55, s42, 3
    s_add_u32 s54, s54, s55
    s_add_u32 s54, s54, s41
    s_lshl_b32 s54, s54, 3
    s_add_u32 s54, s54, 0x2000
    v_mov_b32 v30, s54
    v_mov_b32 v28, s50
    v_mov_b32 v29, s51
    s_mov_b64 exec, 1
    buffer_store_dwordx2 v[28:29], v30, s[24:27], 0 offen sc1
    s_mov_b64 exec, -1
    s_branch Lback_16
Lout_18:
    s_lshl_b32 s54, s41, 4
    s_and_b32 s55, s44, 1
    s_lshl_b32 s55, s55, 3
    s_add_u32 s54, s54, s55
    s_lshl_b32 s54, s54, 9
    s_add_u32 s54, s54, 0x90000
    v_add_u32 v29, s54, v18
    s_mov_b32 s55, 0
    buffer_load_dwordx4 v[80:83], v29, s[24:27], s55 offen sc1
    s_mov_b32 s55, 1024
    buffer_load_dwordx4 v[84:87], v29, s[24:27], s55 offen sc1
    s_mov_b32 s55, 2048
    buffer_load_dwordx4 v[88:91], v29, s[24:27], s55 offen sc1
    s_mov_b32 s55, 3072
    buffer_load_dwordx4 v[92:95], v29, s[24:27], s55 offen sc1
    s_branch Lback_19
Lgr_20:
    s_mov_b32 s57, 0
Lgl_22:
    s_lshl_b32 s54, s41, 4
    s_and_b32 s55, s44, 1
    s_lshl_b32 s55, s55, 3
    s_add_u32 s54, s54, s55
    s_lshl_b32 s54, s54, 2
    s_lshr_b32 s55, s44, 1
    s_add_u32 s54, s54, s55
    s_lshl_b32 s54, s54, 10
    s_add_u32 s54, s54, 0x10000
    v_add_u32 v31, s54, v18
    s_mov_b32 s55, 0
    buffer_load_dwordx4 v[224:227], v31, s[24:27], s55 offen sc1
    s_mov_b32 s55, 4096
    buffer_load_dwordx4 v[228:231], v31, s[24:27], s55 offen sc1
    s_mov_b32 s55, 8192
    buffer_load_dwordx4 v[232:235], v31, s[24:27], s55 offen sc1
    s_mov_b32 s55, 12288
    buffer_load_dwordx4 v[236:239], v31, s[24:27], s55 offen sc1
    s_mov_b32 s55, 16384
    buffer_load_dwordx4 v[240:243], v31, s[24:27], s55 offen sc1
    s_mov_b32 s55, 20480
    buffer_load_dwordx4 v[244:247], v31, s[24:27], s55 offen sc1
    s_mov_b32 s55, 24576
    buffer_load_dwordx4 v[248:251], v31, s[24:27], s55 offen sc1
    s_mov_b32 s55, 28672
    buffer_load_dwordx4 v[252:255], v31, s[24:27], s55 offen sc1
    s_waitcnt vmcnt(0)
    v_max3_u32 v56, v224, v225, v226
    v_max3_u32 v56, v56, v227, v228
    v_max3_u32 v56, v56, v229, v230
    v_max3_u32 v56, v56, v231, v232
    v_max3_u32 v56, v56, v233, v234
    v_max3_u32 v56, v56, v235, v236
    v_max3_u32 v56, v56, v237, v238
    v_max3_u32 v56, v56, v239, v240
    v_max3_u32 v56, v56, v241, v242
    v_max3_u32 v56, v56, v243, v244
    v_max3_u32 v56, v56, v245, v246
    v_max3_u32 v56, v56, v247, v248
    v_max3_u32 v56, v56, v249, v250
    v_max3_u32 v56, v56, v251, v252
    v_max3_u32 v56, v56, v253, v254
    v_max_u32 v56, v56, v255
    s_add_u32 s57, s57, 1
    s_cmp_ge_u32 s57, 0x20000
    s_cbranch_scc1 Lgo_21
    v_cmp_eq_u32 vcc, -1, v56
    s_cbranch_vccnz Lgl_22
    s_branch Lgo_21
Lout_23:
    s_waitcnt vmcnt(8)
    s_mov_b32 s57, 0
Lzr_25:
    v_max3_u32 v30, v80, v81, v82
    v_max3_u32 v30, v30, v83, v84
    v_max3_u32 v30, v30, v85, v86
    v_max3_u32 v30, v30, v87, v88
    v_max3_u32 v30, v30, v89, v90
    v_max3_u32 v30, v30, v91, v92
    v_max3_u32 v30, v30, v93, v94
    v_max_u32 v30, v30, v95
    v_cmp_eq_u32 vcc, -1, v30
    s_cbranch_vccz Lzo_26
    s_add_u32 s57, s57, 1
    s_cmp_ge_u32 s57, 0x20000
    s_cbranch_scc1 Lzo_26
    s_lshl_b32 s54, s41, 4
    s_and_b32 s55, s44, 1
    s_lshl_b32 s55, s55, 3
    s_add_u32 s54, s54, s55
    s_lshl_b32 s54, s54, 9
    s_add_u32 s54, s54, 0x90000
    v_add_u32 v29, s54, v18
    s_mov_b32 s55, 0
    buffer_load_dwordx4 v[80:83], v29, s[24:27], s55 offen sc1
    s_mov_b32 s55, 1024
    buffer_load_dwordx4 v[84:87], v29, s[24:27], s55 offen sc1
    s_mov_b32 s55, 2048
    buffer_load_dwordx4 v[88:91], v29, s[24:27], s55 offen sc1
    s_mov_b32 s55, 3072
    buffer_load_dwordx4 v[92:95], v29, s[24:27], s55 offen sc1
    s_waitcnt vmcnt(0)
    s_branch Lzr_25
Lzo_26:
    v_add_f32 v80, v80, v84
    v_add_f32 v81, v81, v85
    v_add_f32 v82, v82, v86
    v_add_f32 v83, v83, v87
    v_add_f32 v88, v88, v92
    v_add_f32 v89, v89, v93
    v_add_f32 v90, v90, v94
    v_add_f32 v91, v91, v95
    v_add_f32 v80, v80, v88
    v_add_f32 v81, v81, v89
    v_add_f32 v82, v82, v90
    v_add_f32 v83, v83, v91
    v_mov_b32 v84, v80
    v_mov_b32 v85, v81
    v_mov_b32 v86, v82
    v_mov_b32 v87, v83
    v_permlane32_swap_b32 v80, v84
    v_permlane32_swap_b32 v81, v85
    v_permlane32_swap_b32 v82, v86
    v_permlane32_swap_b32 v83, v87
    v_add_f32 v80, v80, v84
    v_add_f32 v81, v81, v85
    v_add_f32 v82, v82, v86
    v_add_f32 v83, v83, v87
    s_and_b32 s54, s44, 1
    s_lshl_b32 s54, s54, 9
    s_add_u32 s54, s54, 0x24000
    v_add_u32 v30, s54, v18
    s_mov_b32 exec_hi, 0
    ds_write_b128 v30, v[80:83]
    s_mov_b64 exec, -1
    s_branch Lback_24
Lout_27:
    s_lshr_b32 s54, s47, 1
    s_lshl_b32 s54, s54, 7
    s_add_u32 s54, s54, 0x2000
    v_and_b32 v30, 15, v0
    v_lshlrev_b32 v30, 3, v30
    v_add_u32 v30, s54, v30
    buffer_load_dwordx2 v[22:23], v30, s[24:27], 0 offen sc1
    s_branch Lback_28
Lout_29:
    s_lshl_b32 s54, s40, 4
    s_lshl_b32 s55, s42, 3
    s_add_u32 s54, s54, s55
    s_add_u32 s54, s54, s41
    s_lshl_b32 s54, s54, 3
    s_add_u32 s54, s54, 0x8000
    v_mov_b32 v30, s54
    v_mov_b32 v28, s50
    v_mov_b32 v29, s51
    s_mov_b64 exec, 1
    buffer_store_dwordx2 v[28:29], v30, s[24:27], 0 offen sc1
    s_mov_b64 exec, -1
    s_branch Lback_30
Lout_32:
    s_lshl_b32 s54, s42, 3
    s_add_u32 s54, s54, s41
    s_lshl_b32 s54, s54, 4
    s_add_u32 s54, s54, s40
    s_lshl_b32 s54, s54, 3
    s_add_u32 s54, s54, 0x1000
    v_mov_b32 v30, s54
    v_mov_b32 v28, s50
    v_mov_b32 v29, s51
    s_mov_b64 exec, 1
    buffer_store_dwordx2 v[28:29], v30, s[24:27], 0 offen sc1
    s_mov_b64 exec, -1
    s_branch Lback_33
Lout_34:
    s_lshl_b32 s54, s40, 7
    s_lshl_b32 s55, s41, 4
    s_add_u32 s54, s54, s55
    s_lshl_b32 s54, s54, 2
    s_add_u32 s54, s54, 0x4000
    v_lshlrev_b32 v30, 2, v0
    v_add_u32 v30, s54, v30
    s_mov_b64 exec, 0xffff
    buffer_store_dword v56, v30, s[24:27], 0 offen sc1
    s_mov_b64 exec, -1
    s_branch Lback_35
Lout_36:
    s_xor_b32 s54, s42, 1
    s_lshl_b32 s54, s54, 3
    s_add_u32 s54, s54, s41
    s_lshl_b32 s54, s54, 7
    s_add_u32 s54, s54, 0x1000
    v_and_b32 v30, 15, v0
    v_lshlrev_b32 v30, 3, v30
    v_add_u32 v30, s54, v30
    buffer_load_dwordx2 v[62:63], v30, s[24:27], 0 offen sc1
    s_branch Lback_37
Lout_40:
    v_lshrrev_b32 v30, 4, v0
    v_lshlrev_b32 v30, 4, v30
    buffer_load_dwordx4 v[32:35], v30, s[36:39], s60 offen offset:0
    buffer_load_dwordx4 v[36:39], v30, s[36:39], s60 offen offset:64
    buffer_load_dwordx4 v[40:43], v30, s[36:39], s61 offen offset:0
    buffer_load_dwordx4 v[44:47], v30, s[36:39], s61 offen offset:64
    buffer_load_dwordx4 v[48:51], v30, s[36:39], s62 offen offset:0
    buffer_load_dwordx4 v[52:55], v30, s[36:39], s62 offen offset:64
    buffer_load_dwordx4 v[56:59], v30, s[36:39], s63 offen offset:0
    buffer_load_dwordx4 v[60:63], v30, s[36:39], s63 offen offset:64
    s_branch Lback_41
Lout_42:
    s_waitcnt vmcnt(8)
    s_mov_b32 s57, 0
Lcp_45:
    v_cmp_eq_u64 vcc, s[50:51], v[62:63]
    s_nop 0
    s_cmp_eq_u64 vcc, -1
    s_cbranch_scc1 Lcc_44
    s_xor_b32 s54, s42, 1
    s_lshl_b32 s54, s54, 3
    s_add_u32 s54, s54, s41
    s_lshl_b32 s54, s54, 7
    s_add_u32 s54, s54, 0x1000
    v_and_b32 v30, 15, v0
    v_lshlrev_b32 v30, 3, v30
    v_add_u32 v30, s54, v30
    buffer_load_dwordx2 v[62:63], v30, s[24:27], 0 offen sc1
    s_add_u32 s57, s57, 1
    s_waitcnt vmcnt(0)
    s_cmp_lt_u32 s57, 0x40000
    s_cbranch_scc1 Lcp_45
Lcc_44:
    s_branch Lback_43
Lout_46:
    s_lshl_b32 s54, s41, 12
    s_add_u32 s54, s54, 0xe0000
    v_add_u32 v29, s54, v18
    s_mov_b32 s55, 0
    buffer_load_dwordx4 v[32:35], v29, s[24:27], s55 offen sc1
    s_mov_b32 s55, 1024
    buffer_load_dwordx4 v[36:39], v29, s[24:27], s55 offen sc1
    s_mov_b32 s55, 2048
    buffer_load_dwordx4 v[40:43], v29, s[24:27], s55 offen sc1
    s_mov_b32 s55, 3072
    buffer_load_dwordx4 v[44:47], v29, s[24:27], s55 offen sc1
    s_branch Lback_47
Lout_48:
    v_lshrrev_b32 v30, 4, v0
    v_lshlrev_b32 v30, 4, v30
    s_and_b32 s54, s41, 1
    s_cmp_eq_u32 s54, 1
    s_cbranch_scc1 Lg1_51
    buffer_load_dwordx4 v[132:135], v30, s[36:39], s64 offen offset:0
    buffer_load_dwordx4 v[140:143], v30, s[36:39], s64 offen offset:64
    buffer_load_dwordx4 v[148:151], v30, s[36:39], s65 offen offset:0
    buffer_load_dwordx4 v[156:159], v30, s[36:39], s65 offen offset:64
    buffer_load_dwordx4 v[164:167], v30, s[36:39], s66 offen offset:0
    buffer_load_dwordx4 v[172:175], v30, s[36:39], s66 offen offset:64
    buffer_load_dwordx4 v[180:183], v30, s[36:39], s67 offen offset:0
    buffer_load_dwordx4 v[188:191], v30, s[36:39], s67 offen offset:64
    s_branch Lgl_50
Lg1_51:
    buffer_load_dwordx4 v[128:131], v30, s[36:39], s64 offen offset:0
    buffer_load_dwordx4 v[136:139], v30, s[36:39], s64 offen offset:64
    buffer_load_dwordx4 v[144:147], v30, s[36:39], s65 offen offset:0
    buffer_load_dwordx4 v[152:155], v30, s[36:39], s65 offen offset:64
    buffer_load_dwordx4 v[160:163], v30, s[36:39], s66 offen offset:0
    buffer_load_dwordx4 v[168:171], v30, s[36:39], s66 offen offset:64
    buffer_load_dwordx4 v[176:179], v30, s[36:39], s67 offen offset:0
    buffer_load_dwordx4 v[184:187], v30, s[36:39], s67 offen offset:64
Lgl_50:
    s_branch Lback_49
Lout_52:
    s_waitcnt vmcnt(6)
    s_and_b32 s54, s41, 1
    s_cmp_eq_u32 s54, 1
    s_cbranch_scc1 Lg1_54
    v_mfma_f32_16x16x32_bf16 v[26:29], v[32:35], v[128:131], 0
    v_mfma_f32_16x16x32_bf16 v[26:29], v[36:39], v[136:139], v[26:29]
    v_mfma_f32_16x16x32_bf16 v[26:29], v[40:43], v[144:147], v[26:29]
    v_mfma_f32_16x16x32_bf16 v[26:29], v[44:47], v[152:155], v[26:29]
    v_mfma_f32_16x16x32_bf16 v[26:29], v[48:51], v[160:163], v[26:29]
    v_mfma_f32_16x16x32_bf16 v[26:29], v[52:55], v[168:171], v[26:29]
    v_mfma_f32_16x16x32_bf16 v[26:29], v[56:59], v[176:179], v[26:29]
    v_mfma_f32_16x16x32_bf16 v[26:29], v[60:63], v[184:187], v[26:29]
    v_mfma_f32_16x16x32_bf16 v[26:29], v[132:135], v[192:195], v[26:29]
    v_mfma_f32_16x16x32_bf16 v[26:29], v[140:143], v[200:203], v[26:29]
    v_mfma_f32_16x16x32_bf16 v[26:29], v[148:151], v[208:211], v[26:29]
    v_mfma_f32_16x16x32_bf16 v[26:29], v[156:159], v[216:219], v[26:29]
    v_mfma_f32_16x16x32_bf16 v[26:29], v[164:167], v[224:227], v[26:29]
    v_mfma_f32_16x16x32_bf16 v[26:29], v[172:175], v[232:235], v[26:29]
    v_mfma_f32_16x16x32_bf16 v[26:29], v[180:183], v[240:243], v[26:29]
    v_mfma_f32_16x16x32_bf16 v[26:29], v[188:191], v[248:251], v[26:29]
    s_branch Lg2_55
Lg1_54:
    v_mfma_f32_16x16x32_bf16 v[26:29], v[32:35], v[132:135], 0
    v_mfma_f32_16x16x32_bf16 v[26:29], v[36:39], v[140:143], v[26:29]
    v_mfma_f32_16x16x32_bf16 v[26:29], v[40:43], v[148:151], v[26:29]
    v_mfma_f32_16x16x32_bf16 v[26:29], v[44:47], v[156:159], v[26:29]
    v_mfma_f32_16x16x32_bf16 v[26:29], v[48:51], v[164:167], v[26:29]
    v_mfma_f32_16x16x32_bf16 v[26:29], v[52:55], v[172:175], v[26:29]
    v_mfma_f32_16x16x32_bf16 v[26:29], v[56:59], v[180:183], v[26:29]
    v_mfma_f32_16x16x32_bf16 v[26:29], v[60:63], v[188:191], v[26:29]
    v_mfma_f32_16x16x32_bf16 v[26:29], v[128:131], v[196:199], v[26:29]
    v_mfma_f32_16x16x32_bf16 v[26:29], v[136:139], v[204:207], v[26:29]
    v_mfma_f32_16x16x32_bf16 v[26:29], v[144:147], v[212:215], v[26:29]
    v_mfma_f32_16x16x32_bf16 v[26:29], v[152:155], v[220:223], v[26:29]
    v_mfma_f32_16x16x32_bf16 v[26:29], v[160:163], v[228:231], v[26:29]
    v_mfma_f32_16x16x32_bf16 v[26:29], v[168:171], v[236:239], v[26:29]
    v_mfma_f32_16x16x32_bf16 v[26:29], v[176:179], v[244:247], v[26:29]
    v_mfma_f32_16x16x32_bf16 v[26:29], v[184:187], v[252:255], v[26:29]
Lg2_55:
    s_nop 7
    v_mul_f32 v26, v19, v26
    v_exp_f32_e64 v26, -v26
    s_nop 0
    v_add_f32 v26, 1.0, v26
    v_rcp_f32 v26, v26
    s_lshl_b32 s54, s40, 7
    s_lshl_b32 s55, s41, 4
    s_add_u32 s54, s54, s55
    s_lshl_b32 s54, s54, 2
    s_add_u32 s54, s54, 0x4000
    v_lshlrev_b32 v30, 2, v0
    v_add_u32 v30, s54, v30
    s_mov_b64 exec, 0xffff
    buffer_store_dword v26, v30, s[24:27], 0 offen sc1
    s_mov_b64 exec, -1
    s_branch Lback_53
Lout_56:
    s_lshl_b32 s54, s40, 4
    s_lshl_b32 s55, s42, 3
    s_add_u32 s54, s54, s55
    s_add_u32 s54, s54, s41
    s_lshl_b32 s54, s54, 3
    s_add_u32 s54, s54, 0x2000
    v_mov_b32 v30, s54
    v_mov_b32 v28, s50
    v_mov_b32 v29, s51
    s_mov_b64 exec, 1
    buffer_store_dwordx2 v[28:29], v30, s[24:27], 0 offen sc1
    s_mov_b64 exec, -1
    s_branch Lback_57
Lout_58:
    s_waitcnt vmcnt(12)
    s_mov_b32 s57, 0
Lzr_60:
    v_max3_u32 v30, v32, v33, v34
    v_max3_u32 v30, v30, v35, v36
    v_max3_u32 v30, v30, v37, v38
    v_max3_u32 v30, v30, v39, v40
    v_max3_u32 v30, v30, v41, v42
    v_max3_u32 v30, v30, v43, v44
    v_max3_u32 v30, v30, v45, v46
    v_max_u32 v30, v30, v47
    v_cmp_eq_u32 vcc, -1, v30
    s_cbranch_vccz Lzo_61
    s_add_u32 s57, s57, 1
    s_cmp_ge_u32 s57, 0x20000
    s_cbranch_scc1 Lzo_61
    s_lshl_b32 s54, s41, 12
    s_add_u32 s54, s54, 0xe0000
    v_add_u32 v29, s54, v18
    s_mov_b32 s55, 0
    buffer_load_dwordx4 v[32:35], v29, s[24:27], s55 offen sc1
    s_mov_b32 s55, 1024
    buffer_load_dwordx4 v[36:39], v29, s[24:27], s55 offen sc1
    s_mov_b32 s55, 2048
    buffer_load_dwordx4 v[40:43], v29, s[24:27], s55 offen sc1
    s_mov_b32 s55, 3072
    buffer_load_dwordx4 v[44:47], v29, s[24:27], s55 offen sc1
    s_waitcnt vmcnt(0)
    s_branch Lzr_60
Lzo_61:
    v_add_f32 v32, v32, v36
    v_add_f32 v33, v33, v37
    v_add_f32 v34, v34, v38
    v_add_f32 v35, v35, v39
    v_add_f32 v40, v40, v44
    v_add_f32 v41, v41, v45
    v_add_f32 v42, v42, v46
    v_add_f32 v43, v43, v47
    v_add_f32 v32, v32, v40
    v_add_f32 v33, v33, v41
    v_add_f32 v34, v34, v42
    v_add_f32 v35, v35, v43
    v_mov_b32 v36, v32
    v_mov_b32 v37, v33
    v_mov_b32 v38, v34
    v_mov_b32 v39, v35
    v_permlane32_swap_b32 v32, v36
    v_permlane32_swap_b32 v33, v37
    v_permlane32_swap_b32 v34, v38
    v_permlane32_swap_b32 v35, v39
    v_add_f32 v32, v32, v36
    v_add_f32 v33, v33, v37
    v_add_f32 v34, v34, v38
    v_add_f32 v35, v35, v39
    v_mov_b32 v36, v32
    v_mov_b32 v37, v33
    v_mov_b32 v38, v34
    v_mov_b32 v39, v35
    v_permlane16_swap_b32 v32, v36
    v_permlane16_swap_b32 v33, v37
    v_permlane16_swap_b32 v34, v38
    v_permlane16_swap_b32 v35, v39
    v_add_f32 v32, v32, v36
    v_add_f32 v33, v33, v37
    v_add_f32 v34, v34, v38
    v_add_f32 v35, v35, v39
    v_mov_b32 v20, v32
    v_mov_b32 v21, v33
    v_mov_b32 v22, v34
    v_mov_b32 v23, v35
    s_branch Lback_59
Lgr_62:
    s_mov_b32 s57, 0
Lgl_64:
    s_lshl_b32 s54, s41, 4
    s_and_b32 s55, s44, 3
    s_lshl_b32 s55, s55, 2
    s_add_u32 s54, s54, s55
    s_lshl_b32 s54, s54, 1
    s_lshr_b32 s55, s44, 2
    s_add_u32 s54, s54, s55
    s_lshl_b32 s54, s54, 10
    s_add_u32 s54, s54, 0xa0000
    v_add_u32 v31, s54, v18
    s_mov_b32 s55, 0
    buffer_load_dwordx4 v[112:115], v31, s[24:27], s55 offen sc1
    s_mov_b32 s55, 2048
    buffer_load_dwordx4 v[116:119], v31, s[24:27], s55 offen sc1
    s_mov_b32 s55, 4096
    buffer_load_dwordx4 v[120:123], v31, s[24:27], s55 offen sc1
    s_mov_b32 s55, 6144
    buffer_load_dwordx4 v[124:127], v31, s[24:27], s55 offen sc1
    s_waitcnt vmcnt(0)
    v_max3_u32 v56, v112, v113, v114
    v_max3_u32 v56, v56, v115, v116
    v_max3_u32 v56, v56, v117, v118
    v_max3_u32 v56, v56, v119, v120
    v_max3_u32 v56, v56, v121, v122
    v_max3_u32 v56, v56, v123, v124
    v_max3_u32 v56, v56, v125, v126
    v_max_u32 v56, v56, v127
    s_add_u32 s57, s57, 1
    s_cmp_ge_u32 s57, 0x20000
    s_cbranch_scc1 Lgo_63
    v_cmp_eq_u32 vcc, -1, v56
    s_cbranch_vccnz Lgl_64
    s_branch Lgo_63
Lout_65:
    v_add_u32 v30, 0x24000, v18
    s_mov_b64 exec, 0xffff
    ds_write_b128 v30, v[20:23]
    s_mov_b64 exec, -1
    s_branch Lback_66
Lout_67:
    s_lshr_b32 s54, s47, 1
    s_lshl_b32 s54, s54, 7
    s_add_u32 s54, s54, 0x2000
    v_and_b32 v30, 15, v0
    v_lshlrev_b32 v30, 3, v30
    v_add_u32 v30, s54, v30
    buffer_load_dwordx2 v[22:23], v30, s[24:27], 0 offen sc1
    s_branch Lback_68
Lout_69:
    s_lshl_b32 s54, s40, 4
    s_lshl_b32 s55, s42, 3
    s_add_u32 s54, s54, s55
    s_add_u32 s54, s54, s41
    s_lshl_b32 s54, s54, 3
    s_add_u32 s54, s54, 0x8000
    v_mov_b32 v30, s54
    v_mov_b32 v28, s50
    v_mov_b32 v29, s51
    s_mov_b64 exec, 1
    buffer_store_dwordx2 v[28:29], v30, s[24:27], 0 offen sc1
    s_mov_b64 exec, -1
    s_branch Lback_70
Lout_71:
    s_waitcnt vmcnt(6)
    s_mov_b32 s57, 0
Lcp_74:
    v_cmp_eq_u64 vcc, s[50:51], v[22:23]
    s_nop 0
    s_cmp_eq_u64 vcc, -1
    s_cbranch_scc1 Lcc_73
    s_lshr_b32 s54, s47, 1
    s_lshl_b32 s54, s54, 7
    s_add_u32 s54, s54, 0x2000
    v_and_b32 v30, 15, v0
    v_lshlrev_b32 v30, 3, v30
    v_add_u32 v30, s54, v30
    buffer_load_dwordx2 v[22:23], v30, s[24:27], 0 offen sc1
    s_add_u32 s57, s57, 1
    s_waitcnt vmcnt(0)
    s_cmp_lt_u32 s57, 0x40000
    s_cbranch_scc1 Lcp_74
Lcc_73:
    s_branch Lback_72
Lout_75:
    s_lshr_b32 s54, s47, 1
    s_lshl_b32 s54, s54, 7
    s_add_u32 s54, s54, 0x8000
    v_and_b32 v30, 15, v0
    v_lshlrev_b32 v30, 3, v30
    v_add_u32 v30, s54, v30
    s_mov_b32 s57, 0
    buffer_load_dwordx2 v[56:57], v30, s[24:27], 0 offen sc1
    buffer_load_dwordx2 v[58:59], v30, s[24:27], 0 offen sc1
Lpl_78:
    s_waitcnt vmcnt(1)
    v_cmp_eq_u64 vcc, s[50:51], v[56:57]
    s_nop 0
    s_cmp_eq_u64 vcc, -1
    s_cbranch_scc1 Lpe_77
    buffer_load_dwordx2 v[56:57], v30, s[24:27], 0 offen sc1
    s_waitcnt vmcnt(1)
    v_cmp_eq_u64 vcc, s[50:51], v[58:59]
    s_nop 0
    s_cmp_eq_u64 vcc, -1
    s_cbranch_scc1 Lpe_77
    buffer_load_dwordx2 v[58:59], v30, s[24:27], 0 offen sc1
    s_add_u32 s57, s57, 1
    s_cmp_lt_u32 s57, 0x20000
    s_cbranch_scc1 Lpl_78
Lpe_77:
    s_branch Lback_76
Lout_79:
    v_mov_b32 v28, s50
    v_mov_b32 v29, s51
    v_mov_b32 v27, 0
    s_mov_b64 exec, 1
    buffer_store_dwordx2 v[28:29], v27, s[24:27], 0 offen
    s_mov_b64 exec, -1
    s_branch Lback_80
Lre_82:
    s_add_u32 s53, s53, 1
    s_cmp_lt_u32 s53, 0x4000
    s_cbranch_scc0 Lok_81
    s_barrier
    s_add_u32 m0, s76, 0
    s_nop 0
    buffer_load_dwordx4 v20, s[24:27], s60 offen sc1 lds
    s_add_u32 m0, s76, 1024
    s_nop 0
    buffer_load_dwordx4 v21, s[24:27], s60 offen sc1 lds
    s_add_u32 m0, s76, 16384
    s_nop 0
    buffer_load_dwordx4 v20, s[24:27], s61 offen sc1 lds
    s_add_u32 m0, s76, 17408
    s_nop 0
    buffer_load_dwordx4 v21, s[24:27], s61 offen sc1 lds
    s_add_u32 m0, s76, 32768
    s_nop 0
    buffer_load_dwordx4 v20, s[24:27], s62 offen sc1 lds
    s_add_u32 m0, s76, 33792
    s_nop 0
    buffer_load_dwordx4 v21, s[24:27], s62 offen sc1 lds
    buffer_load_dword v25, v24, s[24:27], 0 offen sc1
    s_branch L_p3r
L_code_end:
    s_endpgm
.section .rodata,"a"
.p2align 6
.amdhsa_kernel gated_mix__linear_attn_block__linear_kernel_hedgehog__prompt_kernel
  .amdhsa_next_free_vgpr 256
  .amdhsa_next_free_sgpr 102
  .amdhsa_accum_offset 256
  .amdhsa_group_segment_fixed_size 0
  .amdhsa_kernarg_size 88
  .amdhsa_user_sgpr_count 2
  .amdhsa_user_sgpr_kernarg_segment_ptr 1
  .amdhsa_system_sgpr_workgroup_id_x 1
  .amdhsa_float_denorm_mode_32 3
.end_amdhsa_kernel
```
